```python
import torch

def _softmax(x, axis=-1):
    return torch.softmax(x, dim=axis)
def _gelu(x):
    return torch.nn.functional.gelu(x, approximate="tanh")
def _silu(x):
    return torch.nn.functional.silu(x)
def _sigmoid(x):
    return torch.sigmoid(x)
def _layernorm(x, axis=-1, eps=1e-5):
    m = x.mean(dim=axis, keepdim=True)
    v = x.var(dim=axis, keepdim=True, unbiased=False)
    return (x - m) / torch.sqrt(v + eps)
def _scatter_add(tgt, idx, src, axis=0):
    return tgt.clone().index_add_(axis, idx, src)
def _segment_sum(src, seg, n):
    out = torch.zeros((n,) + src.shape[1:], dtype=src.dtype)
    return out.index_add_(0, seg, src)
def _pad(x, pw):
    flat = tuple(v for pair in reversed(pw) for v in pair)
    return torch.nn.functional.pad(x, flat)

kernel_name = 'standalone__mha_softmax__near_ridge'

def setup_inputs():

    _w = (lambda a: (lambda t: t.to(torch.bfloat16) if t.is_floating_point() else t)(torch.as_tensor(a)))
    B, H, Sq, Sk, D = 32, 32, 256, 256, 192
    return {
        "q": _w((lambda *s: torch.randn(*s, dtype=torch.bfloat16) * 0.8)(B, H, Sq, D)),
        "k": _w((lambda *s: torch.randn(*s, dtype=torch.bfloat16) * 0.8)(B, H, Sk, D)),
        "v": _w((lambda *s: torch.randn(*s, dtype=torch.bfloat16) * 0.05)(B, H, Sk, D)),
    }

def reference(q, k, v):
    scale = q.shape[-1] ** -0.5
    scores = torch.einsum("bhqd,bhkd->bhqk", q, k) * scale
    p = _softmax(scores, axis=-1)
    return torch.einsum("bhqk,bhkd->bhqd", p, v)
```

```asm
; @launch grid=(256,1,1) block=(512,1,1) lds=147584
.amdgcn_target "amdgcn-amd-amdhsa--gfx950"
.text
.globl standalone__mha_softmax__near_ridge_kernel
.p2align 8
.type standalone__mha_softmax__near_ridge_kernel,@function
standalone__mha_softmax__near_ridge_kernel:
    s_cmp_ge_u32 s2, 256
    s_cbranch_scc1 L_end
    s_load_dwordx8 s[4:11], s[0:1], 0
    s_load_dwordx2 s[72:73], s[0:1], 40
    v_and_b32 v1, 63, v0
    v_lshrrev_b32 v2, 6, v0
    v_lshrrev_b32 v3, 3, v1
    v_readfirstlane_b32 s32, v2
    v_and_b32 v4, 7, v1
    v_and_b32 v5, 1, v2
    v_mul_u32_u24 v6, 3072, v2
    v_lshl_add_u32 v6, v3, 7, v6
    v_add_u32 v7, 0, v3
    v_mul_u32_u24 v7, 11, v7
    v_lshrrev_b32 v7, 5, v7
    v_and_or_b32 v8, v7, 6, v5
    v_xor_b32 v8, v8, v4
    v_lshl_add_u32 v244, v8, 4, v6
    v_add_u32 v7, 8, v3
    v_mul_u32_u24 v7, 11, v7
    v_lshrrev_b32 v7, 5, v7
    v_and_or_b32 v8, v7, 6, v5
    v_xor_b32 v8, v8, v4
    v_lshl_add_u32 v245, v8, 4, v6
    v_add_u32 v7, 16, v3
    v_mul_u32_u24 v7, 11, v7
    v_lshrrev_b32 v7, 5, v7
    v_and_or_b32 v8, v7, 6, v5
    v_xor_b32 v8, v8, v4
    v_lshl_add_u32 v246, v8, 4, v6
    v_lshrrev_b32 v8, 5, v1
    v_lshl_add_u32 v11, v2, 5, v4
    v_mul_u32_u24 v11, 384, v11
    v_and_b32 v12, 1, v3
    v_lshl_add_u32 v11, v12, 6, v11
    v_bfe_u32 v12, v1, 4, 1
    v_lshl_add_u32 v11, v12, 5, v11
    v_lshl_add_u32 v253, v8, 4, v11
    s_mul_i32 s33, s32, 3072
    s_add_u32 s33, s33, 128
    s_mov_b32 s36, s33
    s_add_u32 s45, s33, 147456
    s_mul_i32 s34, s2, 98304
    s_waitcnt lgkmcnt(0)
    s_mov_b32 s12, s4
    s_and_b32 s13, s5, 0xffff
    s_mov_b32 s14, 100663296
    s_mov_b32 s15, 0x20000
    s_mov_b32 s16, s6
    s_and_b32 s17, s7, 0xffff
    s_mov_b32 s18, 100663296
    s_mov_b32 s19, 0x20000
    s_mov_b32 s20, s8
    s_and_b32 s21, s9, 0xffff
    s_mov_b32 s22, 100663296
    s_mov_b32 s23, 0x20000
    s_mov_b32 s24, s10
    s_and_b32 s25, s11, 0xffff
    s_mov_b32 s26, 0
    s_mov_b32 s27, 0x20000
    s_cmp_ge_u32 s32, 4
    s_cbranch_scc1 L_grpB
    s_mov_b32 m0, s36
    s_nop 0
    buffer_load_dwordx4 v244, s[16:19], s34 offen nt lds
    buffer_load_dwordx4 v245, s[16:19], s34 offen offset:1024 nt lds
    buffer_load_dwordx4 v246, s[16:19], s34 offen offset:2048 nt lds
    s_add_u32 s36, s36, 24576
    s_cmp_eq_u32 s36, s45
    s_cselect_b32 s36, s33, s36
    s_add_u32 s41, s34, 6144
    buffer_load_dwordx4 v[132:135], v253, s[12:15], s34 offen nt
    buffer_load_dwordx4 v[136:139], v253, s[12:15], s34 offen offset:3072 nt
    buffer_load_dwordx4 v[140:143], v253, s[12:15], s41 offen nt
    buffer_load_dwordx4 v[144:147], v253, s[12:15], s41 offen offset:3072 nt
    buffer_load_dwordx4 v[148:151], v253, s[12:15], s34 offen offset:128 nt
    buffer_load_dwordx4 v[152:155], v253, s[12:15], s34 offen offset:3200 nt
    buffer_load_dwordx4 v[156:159], v253, s[12:15], s41 offen offset:128 nt
    buffer_load_dwordx4 v[160:163], v253, s[12:15], s41 offen offset:3200 nt
    buffer_load_dwordx4 v[164:167], v253, s[12:15], s34 offen offset:256 nt
    buffer_load_dwordx4 v[168:171], v253, s[12:15], s34 offen offset:3328 nt
    buffer_load_dwordx4 v[172:175], v253, s[12:15], s41 offen offset:256 nt
    buffer_load_dwordx4 v[176:179], v253, s[12:15], s41 offen offset:3328 nt
    s_add_u32 s36, s33, 98304
    s_and_b32 s73, s73, 0xffff
    s_mov_b32 s74, 402653184
    s_mov_b32 s75, 0x20000
    s_lshr_b32 s76, s2, 4
    s_mul_i32 s76, s76, 4352
    s_add_u32 s76, s76, 0x200000
    s_cmp_eq_u32 s32, 0
    s_cselect_b32 s78, 1, 0
    s_mov_b32 s79, 0
    s_mov_b32 s80, 0
    s_mov_b32 s82, 0
    s_mov_b64 exec, s[78:79]
    v_mov_b32 v254, 0x7fff
    v_mov_b32 v7, 0
    ds_write_b32 v7, v254
    buffer_load_dword v254, off, s[72:75], s76 sc1
    s_mov_b64 exec, -1
    v_and_b32 v7, 15, v1
    v_bfe_u32 v9, v7, 3, 1
    v_and_or_b32 v9, v7, 6, v9
    v_bfe_u32 v10, v1, 4, 1
    v_lshl_or_b32 v10, v10, 1, v8
    v_xor_b32 v9, v9, v10
    v_mul_u32_u24 v10, 384, v7
    v_lshl_add_u32 v247, v9, 4, v10
    v_lshrrev_b32 v7, 2, v1
    v_and_or_b32 v9, v7, 6, v8
    v_bfe_u32 v10, v1, 1, 1
    v_xor_b32 v9, v9, v10
    v_mul_u32_u24 v10, 384, v7
    v_lshl_add_u32 v10, v9, 4, v10
    v_and_b32 v11, 1, v1
    v_lshl_add_u32 v248, v11, 3, v10
    v_mov_b32 v232, 0x3f803f80
    v_mov_b32 v233, 0x3f803f80
    v_mov_b32 v234, 0x3f803f80
    v_mov_b32 v235, 0x3f803f80
    s_mov_b32 s37, 128
    s_mov_b32 s29, -122880
    s_mov_b32 s38, 4
    s_mov_b32 s39, 0x3dd53b95
    s_mov_b32 s40, 0xbdd53b95
    s_add_u32 s35, s34, 25165824
    s_add_u32 s42, s35, 6144
    s_mov_b32 s43, s34
    s_mov_b32 s44, s34
    s_mov_b32 vcc_lo, 0x00ff00ff
    s_mov_b32 vcc_hi, 0x00ff00ff
    s_waitcnt vmcnt(13)
    s_barrier
    v_add_u32 v249, s37, v247
    v_xor_b32 v251, 64, v249
    s_nop 0
    ds_read_b128 v[212:215], v249 offset:0
    ds_read_b128 v[216:219], v249 offset:6144
    ds_read_b128 v[220:223], v249 offset:12288
    ds_read_b128 v[224:227], v249 offset:18432
    ds_read_b128 v[228:231], v251 offset:0
    s_add_u32 s37, s37, 24576
    s_cmp_eq_u32 s37, 147584
    s_cselect_b32 s37, 128, s37
    s_cselect_b32 s28, s29, 24576
    s_waitcnt vmcnt(9)
    v_cndmask_b32_dpp v128, v136, v132, vcc row_ror:8 row_mask:0xf bank_mask:0xf
    v_cndmask_b32_dpp v129, v137, v133, vcc row_ror:8 row_mask:0xf bank_mask:0xf
    v_cndmask_b32_dpp v130, v138, v134, vcc row_ror:8 row_mask:0xf bank_mask:0xf
    v_cndmask_b32_dpp v131, v139, v135, vcc row_ror:8 row_mask:0xf bank_mask:0xf
    v_mov_b32_dpp v136, v132 row_ror:8 row_mask:0xf bank_mask:0x3
    v_mov_b32_dpp v137, v133 row_ror:8 row_mask:0xf bank_mask:0x3
    v_mov_b32_dpp v138, v134 row_ror:8 row_mask:0xf bank_mask:0x3
    v_mov_b32_dpp v139, v135 row_ror:8 row_mask:0xf bank_mask:0x3
    v_cndmask_b32_dpp v132, v144, v140, vcc row_ror:8 row_mask:0xf bank_mask:0xf
    v_cndmask_b32_dpp v133, v145, v141, vcc row_ror:8 row_mask:0xf bank_mask:0xf
    v_cndmask_b32_dpp v134, v146, v142, vcc row_ror:8 row_mask:0xf bank_mask:0xf
    v_cndmask_b32_dpp v135, v147, v143, vcc row_ror:8 row_mask:0xf bank_mask:0xf
    v_mov_b32_dpp v144, v140 row_ror:8 row_mask:0xf bank_mask:0x3
    v_mov_b32_dpp v145, v141 row_ror:8 row_mask:0xf bank_mask:0x3
    v_mov_b32_dpp v146, v142 row_ror:8 row_mask:0xf bank_mask:0x3
    v_mov_b32_dpp v147, v143 row_ror:8 row_mask:0xf bank_mask:0x3
    s_waitcnt vmcnt(5)
    v_cndmask_b32_dpp v140, v152, v148, vcc row_ror:8 row_mask:0xf bank_mask:0xf
    v_cndmask_b32_dpp v141, v153, v149, vcc row_ror:8 row_mask:0xf bank_mask:0xf
    v_cndmask_b32_dpp v142, v154, v150, vcc row_ror:8 row_mask:0xf bank_mask:0xf
    v_cndmask_b32_dpp v143, v155, v151, vcc row_ror:8 row_mask:0xf bank_mask:0xf
    v_mov_b32_dpp v152, v148 row_ror:8 row_mask:0xf bank_mask:0x3
    v_mov_b32_dpp v153, v149 row_ror:8 row_mask:0xf bank_mask:0x3
    v_mov_b32_dpp v154, v150 row_ror:8 row_mask:0xf bank_mask:0x3
    v_mov_b32_dpp v155, v151 row_ror:8 row_mask:0xf bank_mask:0x3
    v_cndmask_b32_dpp v148, v160, v156, vcc row_ror:8 row_mask:0xf bank_mask:0xf
    v_cndmask_b32_dpp v149, v161, v157, vcc row_ror:8 row_mask:0xf bank_mask:0xf
    v_cndmask_b32_dpp v150, v162, v158, vcc row_ror:8 row_mask:0xf bank_mask:0xf
    v_cndmask_b32_dpp v151, v163, v159, vcc row_ror:8 row_mask:0xf bank_mask:0xf
    v_mov_b32_dpp v160, v156 row_ror:8 row_mask:0xf bank_mask:0x3
    v_mov_b32_dpp v161, v157 row_ror:8 row_mask:0xf bank_mask:0x3
    v_mov_b32_dpp v162, v158 row_ror:8 row_mask:0xf bank_mask:0x3
    v_mov_b32_dpp v163, v159 row_ror:8 row_mask:0xf bank_mask:0x3
    s_waitcnt vmcnt(1)
    v_cndmask_b32_dpp v156, v168, v164, vcc row_ror:8 row_mask:0xf bank_mask:0xf
    v_cndmask_b32_dpp v157, v169, v165, vcc row_ror:8 row_mask:0xf bank_mask:0xf
    v_cndmask_b32_dpp v158, v170, v166, vcc row_ror:8 row_mask:0xf bank_mask:0xf
    v_cndmask_b32_dpp v159, v171, v167, vcc row_ror:8 row_mask:0xf bank_mask:0xf
    v_mov_b32_dpp v168, v164 row_ror:8 row_mask:0xf bank_mask:0x3
    v_mov_b32_dpp v169, v165 row_ror:8 row_mask:0xf bank_mask:0x3
    v_mov_b32_dpp v170, v166 row_ror:8 row_mask:0xf bank_mask:0x3
    v_mov_b32_dpp v171, v167 row_ror:8 row_mask:0xf bank_mask:0x3
    v_cndmask_b32_dpp v164, v176, v172, vcc row_ror:8 row_mask:0xf bank_mask:0xf
    v_cndmask_b32_dpp v165, v177, v173, vcc row_ror:8 row_mask:0xf bank_mask:0xf
    v_cndmask_b32_dpp v166, v178, v174, vcc row_ror:8 row_mask:0xf bank_mask:0xf
    v_cndmask_b32_dpp v167, v179, v175, vcc row_ror:8 row_mask:0xf bank_mask:0xf
    v_mov_b32_dpp v176, v172 row_ror:8 row_mask:0xf bank_mask:0x3
    v_mov_b32_dpp v177, v173 row_ror:8 row_mask:0xf bank_mask:0x3
    v_mov_b32_dpp v178, v174 row_ror:8 row_mask:0xf bank_mask:0x3
    v_mov_b32_dpp v179, v175 row_ror:8 row_mask:0xf bank_mask:0x3
    s_waitcnt vmcnt(0)
    v_readfirstlane_b32 s77, v254
.p2align 6
L_headA:
    s_waitcnt lgkmcnt(3)
    v_mfma_f32_16x16x32_bf16 v[0:3], v[212:215], v[128:131], 0
    s_cmp_eq_u32 s38, 1
    s_cbranch_scc1 L_c1
    s_waitcnt vmcnt(5)
    buffer_store_dwordx4 v[184:187], v253, s[24:27], s43 offen offset:3328 sc1
L_c1:
    v_mfma_f32_16x16x32_bf16 v[8:11], v[212:215], v[132:135], 0
    ds_read_b128 v[212:215], v251 offset:6144
    v_mfma_f32_16x16x32_bf16 v[4:7], v[216:219], v[128:131], 0
    v_mfma_f32_16x16x32_bf16 v[12:15], v[216:219], v[132:135], 0
    ds_read_b128 v[216:219], v251 offset:12288
    s_waitcnt lgkmcnt(3)
    v_mfma_f32_16x16x32_bf16 v[16:19], v[220:223], v[128:131], 0
    v_mfma_f32_16x16x32_bf16 v[24:27], v[220:223], v[132:135], 0
    ds_read_b128 v[220:223], v251 offset:18432
    v_mfma_f32_16x16x32_bf16 v[20:23], v[224:227], v[128:131], 0
    v_mfma_f32_16x16x32_bf16 v[28:31], v[224:227], v[132:135], 0
    ds_read_b128 v[224:227], v249 offset:128
    s_waitcnt lgkmcnt(3)
    v_mfma_f32_16x16x32_bf16 v[0:3], v[228:231], v[136:139], v[0:3]
    v_mfma_f32_16x16x32_bf16 v[8:11], v[228:231], v[144:147], v[8:11]
    ds_read_b128 v[228:231], v249 offset:6272
    v_mfma_f32_16x16x32_bf16 v[4:7], v[212:215], v[136:139], v[4:7]
    s_cmp_eq_u32 s38, 1
    s_cbranch_scc1 L_c2
    s_waitcnt vmcnt(5)
    buffer_store_dwordx4 v[180:183], v253, s[24:27], s44 offen offset:256 sc1
L_c2:
    v_mfma_f32_16x16x32_bf16 v[12:15], v[212:215], v[144:147], v[12:15]
    ds_read_b128 v[212:215], v249 offset:12416
    s_waitcnt lgkmcnt(3)
    v_mfma_f32_16x16x32_bf16 v[16:19], v[216:219], v[136:139], v[16:19]
    v_mfma_f32_16x16x32_bf16 v[24:27], v[216:219], v[144:147], v[24:27]
    ds_read_b128 v[216:219], v249 offset:18560
    v_mfma_f32_16x16x32_bf16 v[20:23], v[220:223], v[136:139], v[20:23]
    v_mfma_f32_16x16x32_bf16 v[28:31], v[220:223], v[144:147], v[28:31]
    ds_read_b128 v[220:223], v251 offset:128
    s_waitcnt lgkmcnt(3)
    v_mfma_f32_16x16x32_bf16 v[0:3], v[224:227], v[140:143], v[0:3]
    v_mfma_f32_16x16x32_bf16 v[8:11], v[224:227], v[148:151], v[8:11]
    ds_read_b128 v[224:227], v251 offset:6272
    v_mfma_f32_16x16x32_bf16 v[4:7], v[228:231], v[140:143], v[4:7]
    v_mfma_f32_16x16x32_bf16 v[12:15], v[228:231], v[148:151], v[12:15]
    ds_read_b128 v[228:231], v251 offset:12416
    s_waitcnt lgkmcnt(3)
    v_mfma_f32_16x16x32_bf16 v[16:19], v[212:215], v[140:143], v[16:19]
    s_cmp_eq_u32 s38, 1
    s_cbranch_scc1 L_c3
    s_waitcnt vmcnt(5)
    buffer_store_dwordx4 v[192:195], v253, s[24:27], s44 offen offset:3328 sc1
L_c3:
    v_mfma_f32_16x16x32_bf16 v[24:27], v[212:215], v[148:151], v[24:27]
    ds_read_b128 v[212:215], v251 offset:18560
    v_mfma_f32_16x16x32_bf16 v[20:23], v[216:219], v[140:143], v[20:23]
    v_mfma_f32_16x16x32_bf16 v[28:31], v[216:219], v[148:151], v[28:31]
    ds_read_b128 v[216:219], v249 offset:256
    s_waitcnt lgkmcnt(3)
    v_mfma_f32_16x16x32_bf16 v[0:3], v[220:223], v[152:155], v[0:3]
    v_mfma_f32_16x16x32_bf16 v[8:11], v[220:223], v[160:163], v[8:11]
    ds_read_b128 v[220:223], v249 offset:6400
    v_mfma_f32_16x16x32_bf16 v[4:7], v[224:227], v[152:155], v[4:7]
    v_mfma_f32_16x16x32_bf16 v[12:15], v[224:227], v[160:163], v[12:15]
    ds_read_b128 v[224:227], v249 offset:12544
    s_waitcnt lgkmcnt(3)
    v_mfma_f32_16x16x32_bf16 v[16:19], v[228:231], v[152:155], v[16:19]
    v_mfma_f32_16x16x32_bf16 v[24:27], v[228:231], v[160:163], v[24:27]
    ds_read_b128 v[228:231], v249 offset:18688
    v_mfma_f32_16x16x32_bf16 v[20:23], v[212:215], v[152:155], v[20:23]
    v_mfma_f32_16x16x32_bf16 v[28:31], v[212:215], v[160:163], v[28:31]
    ds_read_b128 v[212:215], v251 offset:256
    s_waitcnt lgkmcnt(3)
    v_mfma_f32_16x16x32_bf16 v[0:3], v[216:219], v[156:159], v[0:3]
    v_add_u32 v249, s28, v249
    v_mfma_f32_16x16x32_bf16 v[8:11], v[216:219], v[164:167], v[8:11]
    ds_read_b128 v[216:219], v251 offset:6400
    v_mfma_f32_16x16x32_bf16 v[4:7], v[220:223], v[156:159], v[4:7]
    v_mfma_f32_16x16x32_bf16 v[12:15], v[220:223], v[164:167], v[12:15]
    ds_read_b128 v[220:223], v251 offset:12544
    s_waitcnt lgkmcnt(3)
    v_mfma_f32_16x16x32_bf16 v[16:19], v[224:227], v[156:159], v[16:19]
    v_mfma_f32_16x16x32_bf16 v[24:27], v[224:227], v[164:167], v[24:27]
    s_cmp_ge_u32 s80, 3
    s_cbranch_scc1 L_tg4
L_tb4:
    s_barrier
    ds_read_b128 v[224:227], v251 offset:18688
    v_mfma_f32_16x16x32_bf16 v[20:23], v[228:231], v[156:159], v[20:23]
    v_mov_b32 v254, 1
    s_mov_b64 exec, s[78:79]
    buffer_atomic_add v254, off, s[72:75], s76 sc0 sc1
    s_mov_b64 exec, -1
    v_mfma_f32_16x16x32_bf16 v[28:31], v[228:231], v[164:167], v[28:31]
    ds_read_b128 v[228:231], v249 offset:0
    s_waitcnt lgkmcnt(3)
    v_mfma_f32_16x16x32_bf16 v[0:3], v[212:215], v[168:171], v[0:3]
    v_add_u32 v251, s28, v251
    v_mfma_f32_16x16x32_bf16 v[8:11], v[212:215], v[176:179], v[8:11]
    ds_read_b128 v[212:215], v249 offset:6144
    v_mfma_f32_16x16x32_bf16 v[4:7], v[216:219], v[168:171], v[4:7]
    s_add_u32 s37, s37, 24576
    s_cmp_eq_u32 s37, 147584
    v_mfma_f32_16x16x32_bf16 v[12:15], v[216:219], v[176:179], v[12:15]
    ds_read_b128 v[216:219], v249 offset:12288
    s_waitcnt lgkmcnt(3)
    v_mfma_f32_16x16x32_bf16 v[16:19], v[220:223], v[168:171], v[16:19]
    s_cselect_b32 s37, 128, s37
    s_cselect_b32 s28, s29, 24576
    v_mfma_f32_16x16x32_bf16 v[24:27], v[220:223], v[176:179], v[24:27]
    ds_read_b128 v[220:223], v249 offset:18432
    v_mfma_f32_16x16x32_bf16 v[20:23], v[224:227], v[168:171], v[20:23]
    v_mfma_f32_16x16x32_bf16 v[28:31], v[224:227], v[176:179], v[28:31]
    ds_read_b128 v[224:227], v251 offset:0
    s_waitcnt lgkmcnt(3)
    v_mfma_f32_16x16x32_bf16 v[32:35], v[228:231], v[128:131], 0
    v_mfma_f32_16x16x32_bf16 v[40:43], v[228:231], v[132:135], 0
    ds_read_b128 v[228:231], v251 offset:6144
    v_mfma_f32_16x16x32_bf16 v[36:39], v[212:215], v[128:131], 0
    v_mfma_f32_16x16x32_bf16 v[44:47], v[212:215], v[132:135], 0
    ds_read_b128 v[212:215], v251 offset:12288
    s_waitcnt lgkmcnt(3)
    v_mfma_f32_16x16x32_bf16 v[48:51], v[216:219], v[128:131], 0
    v_mfma_f32_16x16x32_bf16 v[56:59], v[216:219], v[132:135], 0
    ds_read_b128 v[216:219], v251 offset:18432
    v_mfma_f32_16x16x32_bf16 v[52:55], v[220:223], v[128:131], 0
    v_max_f32 v238, v0, v1
    v_mfma_f32_16x16x32_bf16 v[60:63], v[220:223], v[132:135], 0
    ds_read_b128 v[220:223], v249 offset:128
    s_waitcnt lgkmcnt(3)
    v_mfma_f32_16x16x32_bf16 v[32:35], v[224:227], v[136:139], v[32:35]
    v_max_f32 v239, v8, v9
    v_mfma_f32_16x16x32_bf16 v[40:43], v[224:227], v[144:147], v[40:43]
    ds_read_b128 v[224:227], v249 offset:6272
    v_mfma_f32_16x16x32_bf16 v[36:39], v[228:231], v[136:139], v[36:39]
    s_mov_b32 m0, s36
    s_nop 0
    v_mfma_f32_16x16x32_bf16 v[44:47], v[228:231], v[144:147], v[44:47]
    ds_read_b128 v[228:231], v249 offset:12416
    s_waitcnt lgkmcnt(3)
    v_mfma_f32_16x16x32_bf16 v[48:51], v[212:215], v[136:139], v[48:51]
    s_waitcnt vmcnt(5)
    buffer_load_dwordx4 v244, s[20:23], s34 offen nt lds
    v_mfma_f32_16x16x32_bf16 v[56:59], v[212:215], v[144:147], v[56:59]
    ds_read_b128 v[212:215], v249 offset:18560
    s_waitcnt vmcnt(5)
    buffer_load_dwordx4 v245, s[20:23], s34 offen offset:1024 nt lds
    v_mfma_f32_16x16x32_bf16 v[52:55], v[216:219], v[136:139], v[52:55]
    s_waitcnt vmcnt(5)
    buffer_load_dwordx4 v246, s[20:23], s34 offen offset:2048 nt lds
    v_mfma_f32_16x16x32_bf16 v[60:63], v[216:219], v[144:147], v[60:63]
    ds_read_b128 v[216:219], v251 offset:128
    s_waitcnt lgkmcnt(3)
    v_mfma_f32_16x16x32_bf16 v[32:35], v[220:223], v[140:143], v[32:35]
    v_max3_f32 v238, v238, v2, v3
    v_max3_f32 v239, v239, v10, v11
    v_mfma_f32_16x16x32_bf16 v[40:43], v[220:223], v[148:151], v[40:43]
    ds_read_b128 v[220:223], v251 offset:6272
    v_max3_f32 v238, v238, v4, v5
    v_mfma_f32_16x16x32_bf16 v[36:39], v[224:227], v[140:143], v[36:39]
    v_max3_f32 v239, v239, v12, v13
    v_mfma_f32_16x16x32_bf16 v[44:47], v[224:227], v[148:151], v[44:47]
    ds_read_b128 v[224:227], v251 offset:12416
    s_waitcnt lgkmcnt(3)
    v_mfma_f32_16x16x32_bf16 v[48:51], v[228:231], v[140:143], v[48:51]
    v_max3_f32 v238, v238, v6, v7
    v_mfma_f32_16x16x32_bf16 v[56:59], v[228:231], v[148:151], v[56:59]
    ds_read_b128 v[228:231], v251 offset:18560
    v_mfma_f32_16x16x32_bf16 v[52:55], v[212:215], v[140:143], v[52:55]
    v_max3_f32 v239, v239, v14, v15
    v_mfma_f32_16x16x32_bf16 v[60:63], v[212:215], v[148:151], v[60:63]
    ds_read_b128 v[212:215], v249 offset:256
    s_waitcnt lgkmcnt(3)
    v_mfma_f32_16x16x32_bf16 v[32:35], v[216:219], v[152:155], v[32:35]
    v_mfma_f32_16x16x32_bf16 v[40:43], v[216:219], v[160:163], v[40:43]
    ds_read_b128 v[216:219], v249 offset:6400
    v_mfma_f32_16x16x32_bf16 v[36:39], v[220:223], v[152:155], v[36:39]
    v_max3_f32 v238, v238, v16, v17
    v_mfma_f32_16x16x32_bf16 v[44:47], v[220:223], v[160:163], v[44:47]
    ds_read_b128 v[220:223], v249 offset:12544
    s_waitcnt lgkmcnt(3)
    v_mfma_f32_16x16x32_bf16 v[48:51], v[224:227], v[152:155], v[48:51]
    v_max3_f32 v239, v239, v24, v25
    v_mfma_f32_16x16x32_bf16 v[56:59], v[224:227], v[160:163], v[56:59]
    ds_read_b128 v[224:227], v249 offset:18688
    v_mfma_f32_16x16x32_bf16 v[52:55], v[228:231], v[152:155], v[52:55]
    v_max3_f32 v238, v238, v18, v19
    v_mfma_f32_16x16x32_bf16 v[60:63], v[228:231], v[160:163], v[60:63]
    ds_read_b128 v[228:231], v251 offset:256
    s_waitcnt lgkmcnt(3)
    v_mfma_f32_16x16x32_bf16 v[32:35], v[212:215], v[156:159], v[32:35]
    v_add_u32 v249, s28, v249
    v_max3_f32 v239, v239, v26, v27
    v_mfma_f32_16x16x32_bf16 v[40:43], v[212:215], v[164:167], v[40:43]
    ds_read_b128 v[212:215], v251 offset:6400
    v_mfma_f32_16x16x32_bf16 v[36:39], v[216:219], v[156:159], v[36:39]
    v_mfma_f32_16x16x32_bf16 v[44:47], v[216:219], v[164:167], v[44:47]
    ds_read_b128 v[216:219], v251 offset:12544
    s_waitcnt lgkmcnt(3)
    v_mfma_f32_16x16x32_bf16 v[48:51], v[220:223], v[156:159], v[48:51]
    v_max3_f32 v238, v238, v20, v21
    v_mfma_f32_16x16x32_bf16 v[56:59], v[220:223], v[164:167], v[56:59]
    s_cmp_ge_u32 s80, 2
    s_cbranch_scc1 L_tg5
L_tb5:
    s_barrier
    ds_read_b128 v[220:223], v251 offset:18688
    v_mfma_f32_16x16x32_bf16 v[52:55], v[224:227], v[156:159], v[52:55]
    s_add_u32 m0, s36, 12288
    s_add_u32 s41, s34, 12288
    v_mfma_f32_16x16x32_bf16 v[60:63], v[224:227], v[164:167], v[60:63]
    ds_read_b128 v[224:227], v249 offset:0
    s_waitcnt lgkmcnt(3)
    v_mfma_f32_16x16x32_bf16 v[32:35], v[228:231], v[168:171], v[32:35]
    v_add_u32 v251, s28, v251
    s_waitcnt vmcnt(5)
    buffer_load_dwordx4 v244, s[20:23], s41 offen nt lds
    v_mfma_f32_16x16x32_bf16 v[40:43], v[228:231], v[176:179], v[40:43]
    ds_read_b128 v[228:231], v249 offset:6144
    s_waitcnt vmcnt(5)
    buffer_load_dwordx4 v245, s[20:23], s41 offen offset:1024 nt lds
    v_mfma_f32_16x16x32_bf16 v[36:39], v[212:215], v[168:171], v[36:39]
    s_waitcnt vmcnt(5)
    buffer_load_dwordx4 v246, s[20:23], s41 offen offset:2048 nt lds
    v_mfma_f32_16x16x32_bf16 v[44:47], v[212:215], v[176:179], v[44:47]
    ds_read_b128 v[212:215], v249 offset:12288
    s_waitcnt lgkmcnt(3)
    v_mfma_f32_16x16x32_bf16 v[48:51], v[216:219], v[168:171], v[48:51]
    s_add_u32 s36, s36, 24576
    s_cmp_eq_u32 s36, s45
    v_mfma_f32_16x16x32_bf16 v[56:59], v[216:219], v[176:179], v[56:59]
    ds_read_b128 v[216:219], v249 offset:18432
    s_cselect_b32 s36, s33, s36
    v_mfma_f32_16x16x32_bf16 v[52:55], v[220:223], v[168:171], v[52:55]
    s_add_u32 s37, s37, 24576
    s_cmp_eq_u32 s37, 147584
    v_mfma_f32_16x16x32_bf16 v[60:63], v[220:223], v[176:179], v[60:63]
    ds_read_b128 v[220:223], v251 offset:0
    s_waitcnt lgkmcnt(3)
    v_mfma_f32_16x16x32_bf16 v[64:67], v[224:227], v[128:131], 0
    s_cselect_b32 s37, 128, s37
    s_cselect_b32 s28, s29, 24576
    v_mfma_f32_16x16x32_bf16 v[72:75], v[224:227], v[132:135], 0
    ds_read_b128 v[224:227], v251 offset:6144
    v_max3_f32 v239, v239, v28, v29
    v_mfma_f32_16x16x32_bf16 v[68:71], v[228:231], v[128:131], 0
    v_max3_f32 v238, v238, v22, v23
    v_max3_f32 v239, v239, v30, v31
    v_mfma_f32_16x16x32_bf16 v[76:79], v[228:231], v[132:135], 0
    ds_read_b128 v[228:231], v251 offset:12288
    s_waitcnt lgkmcnt(3)
    v_mfma_f32_16x16x32_bf16 v[80:83], v[212:215], v[128:131], 0
    v_subrev_u32 v254, s77, v254
    s_mov_b64 exec, s[78:79]
    ds_write_b32 v247, v254
    s_mov_b64 exec, -1
    s_add_u32 s77, s77, 16
    v_mfma_f32_16x16x32_bf16 v[88:91], v[212:215], v[132:135], 0
    ds_read_b128 v[212:215], v251 offset:18432
    v_mfma_f32_16x16x32_bf16 v[84:87], v[216:219], v[128:131], 0
    v_max3_f32 v238, v238, v32, v33
    v_mfma_f32_16x16x32_bf16 v[92:95], v[216:219], v[132:135], 0
    ds_read_b128 v[216:219], v249 offset:128
    s_waitcnt lgkmcnt(4)
    v_mfma_f32_16x16x32_bf16 v[64:67], v[220:223], v[136:139], v[64:67]
    v_max3_f32 v239, v239, v40, v41
    v_mfma_f32_16x16x32_bf16 v[72:75], v[220:223], v[144:147], v[72:75]
    ds_read_b128 v[220:223], v249 offset:6272
    v_mfma_f32_16x16x32_bf16 v[68:71], v[224:227], v[136:139], v[68:71]
    v_max3_f32 v238, v238, v34, v35
    v_mfma_f32_16x16x32_bf16 v[76:79], v[224:227], v[144:147], v[76:79]
    ds_read_b128 v[224:227], v249 offset:12416
    s_waitcnt lgkmcnt(3)
    v_mfma_f32_16x16x32_bf16 v[80:83], v[228:231], v[136:139], v[80:83]
    v_max3_f32 v239, v239, v42, v43
    v_mfma_f32_16x16x32_bf16 v[88:91], v[228:231], v[144:147], v[88:91]
    ds_read_b128 v[228:231], v249 offset:18560
    v_mfma_f32_16x16x32_bf16 v[84:87], v[212:215], v[136:139], v[84:87]
    v_mfma_f32_16x16x32_bf16 v[92:95], v[212:215], v[144:147], v[92:95]
    ds_read_b128 v[212:215], v251 offset:128
    s_waitcnt lgkmcnt(3)
    v_mfma_f32_16x16x32_bf16 v[64:67], v[216:219], v[140:143], v[64:67]
    v_max3_f32 v238, v238, v36, v37
    v_mfma_f32_16x16x32_bf16 v[72:75], v[216:219], v[148:151], v[72:75]
    ds_read_b128 v[216:219], v251 offset:6272
    v_mfma_f32_16x16x32_bf16 v[68:71], v[220:223], v[140:143], v[68:71]
    v_max3_f32 v239, v239, v44, v45
    v_mfma_f32_16x16x32_bf16 v[76:79], v[220:223], v[148:151], v[76:79]
    ds_read_b128 v[220:223], v251 offset:12416
    s_waitcnt lgkmcnt(3)
    v_mfma_f32_16x16x32_bf16 v[80:83], v[224:227], v[140:143], v[80:83]
    v_max3_f32 v238, v238, v38, v39
    v_mfma_f32_16x16x32_bf16 v[88:91], v[224:227], v[148:151], v[88:91]
    ds_read_b128 v[224:227], v251 offset:18560
    v_mfma_f32_16x16x32_bf16 v[84:87], v[228:231], v[140:143], v[84:87]
    v_max3_f32 v239, v239, v46, v47
    v_mfma_f32_16x16x32_bf16 v[92:95], v[228:231], v[148:151], v[92:95]
    ds_read_b128 v[228:231], v249 offset:256
    s_waitcnt lgkmcnt(3)
    v_mfma_f32_16x16x32_bf16 v[64:67], v[212:215], v[152:155], v[64:67]
    v_mfma_f32_16x16x32_bf16 v[72:75], v[212:215], v[160:163], v[72:75]
    ds_read_b128 v[212:215], v249 offset:6400
    v_mfma_f32_16x16x32_bf16 v[68:71], v[216:219], v[152:155], v[68:71]
    v_max3_f32 v238, v238, v48, v49
    v_mfma_f32_16x16x32_bf16 v[76:79], v[216:219], v[160:163], v[76:79]
    ds_read_b128 v[216:219], v249 offset:12544
    s_waitcnt lgkmcnt(3)
    v_mfma_f32_16x16x32_bf16 v[80:83], v[220:223], v[152:155], v[80:83]
    v_max3_f32 v239, v239, v56, v57
    v_mfma_f32_16x16x32_bf16 v[88:91], v[220:223], v[160:163], v[88:91]
    ds_read_b128 v[220:223], v249 offset:18688
    v_mfma_f32_16x16x32_bf16 v[84:87], v[224:227], v[152:155], v[84:87]
    v_max3_f32 v238, v238, v50, v51
    v_mfma_f32_16x16x32_bf16 v[92:95], v[224:227], v[160:163], v[92:95]
    ds_read_b128 v[224:227], v251 offset:256
    s_waitcnt lgkmcnt(3)
    v_mfma_f32_16x16x32_bf16 v[64:67], v[228:231], v[156:159], v[64:67]
    v_add_u32 v249, s28, v249
    v_max3_f32 v239, v239, v58, v59
    v_mfma_f32_16x16x32_bf16 v[72:75], v[228:231], v[164:167], v[72:75]
    ds_read_b128 v[228:231], v251 offset:6400
    v_mfma_f32_16x16x32_bf16 v[68:71], v[212:215], v[156:159], v[68:71]
    v_mfma_f32_16x16x32_bf16 v[76:79], v[212:215], v[164:167], v[76:79]
    ds_read_b128 v[212:215], v251 offset:12544
    s_waitcnt lgkmcnt(3)
    v_mfma_f32_16x16x32_bf16 v[80:83], v[216:219], v[156:159], v[80:83]
    v_max3_f32 v238, v238, v52, v53
    v_mfma_f32_16x16x32_bf16 v[88:91], v[216:219], v[164:167], v[88:91]
    s_cmp_ge_u32 s80, 3
    s_cbranch_scc1 L_tg6
L_tb6:
    s_barrier
    ds_read_b128 v[216:219], v251 offset:18688
    v_mfma_f32_16x16x32_bf16 v[84:87], v[220:223], v[156:159], v[84:87]
    ds_read_b32 v254, v247
    v_max3_f32 v239, v239, v60, v61
    v_mfma_f32_16x16x32_bf16 v[92:95], v[220:223], v[164:167], v[92:95]
    ds_read_b128 v[220:223], v249 offset:0
    s_waitcnt lgkmcnt(4)
    v_mfma_f32_16x16x32_bf16 v[64:67], v[224:227], v[168:171], v[64:67]
    v_add_u32 v251, s28, v251
    v_max3_f32 v238, v238, v54, v55
    v_mfma_f32_16x16x32_bf16 v[72:75], v[224:227], v[176:179], v[72:75]
    ds_read_b128 v[224:227], v249 offset:6144
    v_mfma_f32_16x16x32_bf16 v[68:71], v[228:231], v[168:171], v[68:71]
    s_add_u32 s37, s37, 24576
    s_cmp_eq_u32 s37, 147584
    v_mfma_f32_16x16x32_bf16 v[76:79], v[228:231], v[176:179], v[76:79]
    ds_read_b128 v[228:231], v249 offset:12288
    s_waitcnt lgkmcnt(4)
    v_mfma_f32_16x16x32_bf16 v[80:83], v[212:215], v[168:171], v[80:83]
    s_cselect_b32 s37, 128, s37
    s_cselect_b32 s28, s29, 24576
    v_mfma_f32_16x16x32_bf16 v[88:91], v[212:215], v[176:179], v[88:91]
    ds_read_b128 v[212:215], v249 offset:18432
    v_max3_f32 v239, v239, v62, v63
    v_mfma_f32_16x16x32_bf16 v[84:87], v[216:219], v[168:171], v[84:87]
    v_mfma_f32_16x16x32_bf16 v[92:95], v[216:219], v[176:179], v[92:95]
    ds_read_b128 v[216:219], v251 offset:0
    s_waitcnt lgkmcnt(3)
    v_mfma_f32_16x16x32_bf16 v[96:99], v[220:223], v[128:131], 0
    v_mfma_f32_16x16x32_bf16 v[104:107], v[220:223], v[132:135], 0
    ds_read_b128 v[220:223], v251 offset:6144
    v_mfma_f32_16x16x32_bf16 v[100:103], v[224:227], v[128:131], 0
    v_mfma_f32_16x16x32_bf16 v[108:111], v[224:227], v[132:135], 0
    ds_read_b128 v[224:227], v251 offset:12288
    s_waitcnt lgkmcnt(3)
    v_mfma_f32_16x16x32_bf16 v[112:115], v[228:231], v[128:131], 0
    v_mfma_f32_16x16x32_bf16 v[120:123], v[228:231], v[132:135], 0
    ds_read_b128 v[228:231], v251 offset:18432
    v_mfma_f32_16x16x32_bf16 v[116:119], v[212:215], v[128:131], 0
    s_mov_b32 m0, s36
    s_add_u32 s41, s34, 24576
    v_mfma_f32_16x16x32_bf16 v[124:127], v[212:215], v[132:135], 0
    ds_read_b128 v[212:215], v249 offset:128
    s_waitcnt lgkmcnt(3)
    v_mfma_f32_16x16x32_bf16 v[96:99], v[216:219], v[136:139], v[96:99]
    s_waitcnt vmcnt(5)
    buffer_load_dwordx4 v244, s[20:23], s41 offen nt lds
    v_mfma_f32_16x16x32_bf16 v[104:107], v[216:219], v[144:147], v[104:107]
    ds_read_b128 v[216:219], v249 offset:6272
    s_waitcnt vmcnt(5)
    buffer_load_dwordx4 v245, s[20:23], s41 offen offset:1024 nt lds
    v_mfma_f32_16x16x32_bf16 v[100:103], v[220:223], v[136:139], v[100:103]
    s_waitcnt vmcnt(5)
    buffer_load_dwordx4 v246, s[20:23], s41 offen offset:2048 nt lds
    v_mfma_f32_16x16x32_bf16 v[108:111], v[220:223], v[144:147], v[108:111]
    ds_read_b128 v[220:223], v249 offset:12416
    s_waitcnt lgkmcnt(3)
    v_mfma_f32_16x16x32_bf16 v[112:115], v[224:227], v[136:139], v[112:115]
    v_max3_f32 v238, v238, v64, v65
    v_max3_f32 v239, v239, v72, v73
    v_mfma_f32_16x16x32_bf16 v[120:123], v[224:227], v[144:147], v[120:123]
    ds_read_b128 v[224:227], v249 offset:18560
    v_max3_f32 v238, v238, v66, v67
    v_mfma_f32_16x16x32_bf16 v[116:119], v[228:231], v[136:139], v[116:119]
    v_max3_f32 v239, v239, v74, v75
    v_mfma_f32_16x16x32_bf16 v[124:127], v[228:231], v[144:147], v[124:127]
    ds_read_b128 v[228:231], v251 offset:128
    s_waitcnt lgkmcnt(3)
    v_mfma_f32_16x16x32_bf16 v[96:99], v[212:215], v[140:143], v[96:99]
    v_max3_f32 v238, v238, v68, v69
    v_mfma_f32_16x16x32_bf16 v[104:107], v[212:215], v[148:151], v[104:107]
    ds_read_b128 v[212:215], v251 offset:6272
    v_mfma_f32_16x16x32_bf16 v[100:103], v[216:219], v[140:143], v[100:103]
    v_max3_f32 v239, v239, v76, v77
    v_mfma_f32_16x16x32_bf16 v[108:111], v[216:219], v[148:151], v[108:111]
    ds_read_b128 v[216:219], v251 offset:12416
    s_waitcnt lgkmcnt(3)
    v_mfma_f32_16x16x32_bf16 v[112:115], v[220:223], v[140:143], v[112:115]
    v_max3_f32 v238, v238, v70, v71
    v_mfma_f32_16x16x32_bf16 v[120:123], v[220:223], v[148:151], v[120:123]
    ds_read_b128 v[220:223], v251 offset:18560
    v_mfma_f32_16x16x32_bf16 v[116:119], v[224:227], v[140:143], v[116:119]
    v_max3_f32 v239, v239, v78, v79
    v_mfma_f32_16x16x32_bf16 v[124:127], v[224:227], v[148:151], v[124:127]
    ds_read_b128 v[224:227], v249 offset:256
    s_waitcnt lgkmcnt(3)
    v_mfma_f32_16x16x32_bf16 v[96:99], v[228:231], v[152:155], v[96:99]
    v_readfirstlane_b32 s81, v254
    v_mfma_f32_16x16x32_bf16 v[104:107], v[228:231], v[160:163], v[104:107]
    ds_read_b128 v[228:231], v249 offset:6400
    s_cmp_lt_i32 s81, 10
    v_mfma_f32_16x16x32_bf16 v[100:103], v[212:215], v[152:155], v[100:103]
    s_cselect_b32 s80, 1, 0
    s_cmp_lt_i32 s81, 6
    v_mfma_f32_16x16x32_bf16 v[108:111], v[212:215], v[160:163], v[108:111]
    ds_read_b128 v[212:215], v249 offset:12544
    s_waitcnt lgkmcnt(3)
    v_mfma_f32_16x16x32_bf16 v[112:115], v[216:219], v[152:155], v[112:115]
    s_cselect_b32 s80, 2, s80
    s_cmp_lt_i32 s81, 3
    v_mfma_f32_16x16x32_bf16 v[120:123], v[216:219], v[160:163], v[120:123]
    ds_read_b128 v[216:219], v249 offset:18688
    s_cselect_b32 s80, 3, s80
    v_mfma_f32_16x16x32_bf16 v[116:119], v[220:223], v[152:155], v[116:119]
    s_cmp_le_u32 s38, 1
    s_cselect_b32 s81, 2, 9
    v_mfma_f32_16x16x32_bf16 v[124:127], v[220:223], v[160:163], v[124:127]
    ds_read_b128 v[220:223], v251 offset:256
    s_waitcnt lgkmcnt(3)
    v_mfma_f32_16x16x32_bf16 v[96:99], v[224:227], v[156:159], v[96:99]
    s_min_u32 s80, s80, s81
    s_cmp_le_u32 s38, 1
    v_mfma_f32_16x16x32_bf16 v[104:107], v[224:227], v[164:167], v[104:107]
    ds_read_b128 v[224:227], v251 offset:6400
    s_cselect_b32 s81, 1, 9
    v_mfma_f32_16x16x32_bf16 v[100:103], v[228:231], v[156:159], v[100:103]
    s_min_u32 s80, s80, s81
    v_max3_f32 v238, v238, v80, v81
    v_mfma_f32_16x16x32_bf16 v[108:111], v[228:231], v[164:167], v[108:111]
    ds_read_b128 v[228:231], v251 offset:12544
    s_waitcnt lgkmcnt(3)
    v_mfma_f32_16x16x32_bf16 v[112:115], v[212:215], v[156:159], v[112:115]
    v_max3_f32 v239, v239, v88, v89
    v_max3_f32 v238, v238, v82, v83
    v_mfma_f32_16x16x32_bf16 v[120:123], v[212:215], v[164:167], v[120:123]
    ds_read_b128 v[212:215], v251 offset:18688
    v_max3_f32 v239, v239, v90, v91
    v_mfma_f32_16x16x32_bf16 v[116:119], v[216:219], v[156:159], v[116:119]
    v_max3_f32 v238, v238, v84, v85
    v_max3_f32 v239, v239, v92, v93
    v_mfma_f32_16x16x32_bf16 v[124:127], v[216:219], v[164:167], v[124:127]
    s_waitcnt lgkmcnt(2)
    v_mfma_f32_16x16x32_bf16 v[96:99], v[220:223], v[168:171], v[96:99]
    v_max3_f32 v238, v238, v86, v87
    v_mfma_f32_16x16x32_bf16 v[104:107], v[220:223], v[176:179], v[104:107]
    v_mfma_f32_16x16x32_bf16 v[100:103], v[224:227], v[168:171], v[100:103]
    v_max3_f32 v239, v239, v94, v95
    v_mfma_f32_16x16x32_bf16 v[108:111], v[224:227], v[176:179], v[108:111]
    s_waitcnt lgkmcnt(0)
    v_mfma_f32_16x16x32_bf16 v[112:115], v[228:231], v[168:171], v[112:115]
    v_mfma_f32_16x16x32_bf16 v[120:123], v[228:231], v[176:179], v[120:123]
    v_mfma_f32_16x16x32_bf16 v[116:119], v[212:215], v[168:171], v[116:119]
    v_mfma_f32_16x16x32_bf16 v[124:127], v[212:215], v[176:179], v[124:127]
    s_cmp_ge_u32 s80, 1
    s_cbranch_scc1 L_tg7
L_tb7:
    s_barrier
    s_nop 7
    s_nop 2
    s_add_u32 m0, s36, 12288
    s_add_u32 s41, s34, 36864
    s_waitcnt vmcnt(5)
    buffer_load_dwordx4 v244, s[20:23], s41 offen nt lds
    s_waitcnt vmcnt(5)
    buffer_load_dwordx4 v245, s[20:23], s41 offen offset:1024 nt lds
    s_waitcnt vmcnt(5)
    buffer_load_dwordx4 v246, s[20:23], s41 offen offset:2048 nt lds
    s_add_u32 s36, s36, 73728
    s_cmp_ge_u32 s36, s45
    s_cselect_b32 s41, 147456, 0
    s_sub_u32 s36, s36, s41
    v_max3_f32 v238, v238, v96, v97
    v_max3_f32 v239, v239, v104, v105
    v_max3_f32 v238, v238, v98, v99
    v_max3_f32 v239, v239, v106, v107
    v_max3_f32 v238, v238, v100, v101
    v_max3_f32 v239, v239, v108, v109
    v_max3_f32 v238, v238, v102, v103
    v_max3_f32 v239, v239, v110, v111
    v_max3_f32 v238, v238, v112, v113
    v_max3_f32 v239, v239, v120, v121
    v_max3_f32 v238, v238, v114, v115
    v_max3_f32 v239, v239, v122, v123
    v_max3_f32 v238, v238, v116, v117
    v_max3_f32 v239, v239, v124, v125
    v_max3_f32 v238, v238, v118, v119
    v_max3_f32 v239, v239, v126, v127
    s_nop 1
    v_permlane32_swap_b32 v238, v239
    v_max_f32 v238, v238, v239
    v_mov_b32 v239, v238
    s_nop 1
    v_permlane16_swap_b32 v238, v239
    v_max_f32 v238, v238, v239
    v_mul_f32 v240, s40, v238
    v_mov_b32 v241, v240
    s_nop 1
    v_permlane32_swap_b32 v240, v241
    v_fma_f32 v0, v0, s39, v240
    v_fma_f32 v1, v1, s39, v240
    v_fma_f32 v2, v2, s39, v240
    v_fma_f32 v3, v3, s39, v240
    v_exp_f32 v0, v0
    v_exp_f32 v1, v1
    v_fma_f32 v4, v4, s39, v240
    v_fma_f32 v5, v5, s39, v240
    v_exp_f32 v2, v2
    v_exp_f32 v3, v3
    v_cvt_pk_bf16_f32 v0, v0, v1
    v_fma_f32 v6, v6, s39, v240
    v_fma_f32 v7, v7, s39, v240
    v_exp_f32 v4, v4
    v_exp_f32 v5, v5
    v_cvt_pk_bf16_f32 v1, v2, v3
    v_fma_f32 v8, v8, s39, v241
    v_fma_f32 v9, v9, s39, v241
    v_exp_f32 v6, v6
    v_exp_f32 v7, v7
    v_cvt_pk_bf16_f32 v2, v4, v5
    v_fma_f32 v10, v10, s39, v241
    v_fma_f32 v11, v11, s39, v241
    v_exp_f32 v8, v8
    v_exp_f32 v9, v9
    v_cvt_pk_bf16_f32 v3, v6, v7
    v_fma_f32 v12, v12, s39, v241
    v_fma_f32 v13, v13, s39, v241
    v_exp_f32 v10, v10
    v_exp_f32 v11, v11
    v_cvt_pk_bf16_f32 v4, v8, v9
    v_fma_f32 v14, v14, s39, v241
    v_fma_f32 v15, v15, s39, v241
    v_exp_f32 v12, v12
    v_exp_f32 v13, v13
    v_cvt_pk_bf16_f32 v5, v10, v11
    v_fma_f32 v16, v16, s39, v240
    v_fma_f32 v17, v17, s39, v240
    v_exp_f32 v14, v14
    v_exp_f32 v15, v15
    v_cvt_pk_bf16_f32 v6, v12, v13
    v_fma_f32 v18, v18, s39, v240
    v_fma_f32 v19, v19, s39, v240
    v_exp_f32 v16, v16
    v_exp_f32 v17, v17
    v_cvt_pk_bf16_f32 v7, v14, v15
    v_fma_f32 v20, v20, s39, v240
    v_fma_f32 v21, v21, s39, v240
    v_exp_f32 v18, v18
    v_exp_f32 v19, v19
    v_cvt_pk_bf16_f32 v8, v16, v17
    v_fma_f32 v22, v22, s39, v240
    v_fma_f32 v23, v23, s39, v240
    v_exp_f32 v20, v20
    v_exp_f32 v21, v21
    v_cvt_pk_bf16_f32 v9, v18, v19
    v_fma_f32 v24, v24, s39, v241
    v_fma_f32 v25, v25, s39, v241
    v_exp_f32 v22, v22
    v_exp_f32 v23, v23
    v_cvt_pk_bf16_f32 v10, v20, v21
    v_fma_f32 v26, v26, s39, v241
    v_fma_f32 v27, v27, s39, v241
    v_exp_f32 v24, v24
    v_exp_f32 v25, v25
    s_cmp_ge_u32 s80, 3
    s_cbranch_scc1 L_tg8
L_tb8:
    s_barrier
    s_cmp_eq_u32 s38, 1
    s_cbranch_scc1 L_c9
    v_mov_b32 v254, 1
    s_mov_b64 exec, s[78:79]
    buffer_atomic_add v254, off, s[72:75], s76 sc0 sc1
    s_mov_b64 exec, -1
L_c9:
    v_cvt_pk_bf16_f32 v11, v22, v23
    v_fma_f32 v28, v28, s39, v241
    v_fma_f32 v29, v29, s39, v241
    v_exp_f32 v26, v26
    v_exp_f32 v27, v27
    v_cvt_pk_bf16_f32 v12, v24, v25
    v_fma_f32 v30, v30, s39, v241
    v_fma_f32 v31, v31, s39, v241
    v_exp_f32 v28, v28
    v_exp_f32 v29, v29
    v_cvt_pk_bf16_f32 v13, v26, v27
    v_fma_f32 v32, v32, s39, v240
    v_fma_f32 v33, v33, s39, v240
    v_exp_f32 v30, v30
    s_cmp_eq_u32 s38, 1
    s_cbranch_scc1 L_c10
    s_waitcnt vmcnt(5)
    buffer_load_dwordx4 v[132:135], v253, s[12:15], s35 offen nt
L_c10:
    v_exp_f32 v31, v31
    v_cvt_pk_bf16_f32 v14, v28, v29
    v_fma_f32 v34, v34, s39, v240
    v_fma_f32 v35, v35, s39, v240
    v_exp_f32 v32, v32
    v_exp_f32 v33, v33
    v_cvt_pk_bf16_f32 v15, v30, v31
    v_fma_f32 v36, v36, s39, v240
    v_fma_f32 v37, v37, s39, v240
    v_exp_f32 v34, v34
    v_exp_f32 v35, v35
    v_cvt_pk_bf16_f32 v16, v32, v33
    v_fma_f32 v38, v38, s39, v240
    v_fma_f32 v39, v39, s39, v240
    s_cmp_eq_u32 s38, 1
    s_cbranch_scc1 L_c11
    s_waitcnt vmcnt(5)
    buffer_load_dwordx4 v[136:139], v253, s[12:15], s35 offen offset:3072 nt
L_c11:
    v_exp_f32 v36, v36
    v_exp_f32 v37, v37
    v_cvt_pk_bf16_f32 v17, v34, v35
    v_fma_f32 v40, v40, s39, v241
    v_fma_f32 v41, v41, s39, v241
    v_exp_f32 v38, v38
    v_exp_f32 v39, v39
    v_cvt_pk_bf16_f32 v18, v36, v37
    v_fma_f32 v42, v42, s39, v241
    v_fma_f32 v43, v43, s39, v241
    v_exp_f32 v40, v40
    v_exp_f32 v41, v41
    v_cvt_pk_bf16_f32 v19, v38, v39
    v_fma_f32 v44, v44, s39, v241
    v_fma_f32 v45, v45, s39, v241
    s_cmp_eq_u32 s38, 1
    s_cbranch_scc1 L_c12
    s_waitcnt vmcnt(5)
    buffer_load_dwordx4 v[140:143], v253, s[12:15], s42 offen nt
L_c12:
    v_exp_f32 v42, v42
    v_exp_f32 v43, v43
    v_cvt_pk_bf16_f32 v20, v40, v41
    v_fma_f32 v46, v46, s39, v241
    v_fma_f32 v47, v47, s39, v241
    v_exp_f32 v44, v44
    v_exp_f32 v45, v45
    v_cvt_pk_bf16_f32 v21, v42, v43
    v_fma_f32 v48, v48, s39, v240
    v_fma_f32 v49, v49, s39, v240
    v_exp_f32 v46, v46
    v_exp_f32 v47, v47
    v_cvt_pk_bf16_f32 v22, v44, v45
    v_fma_f32 v50, v50, s39, v240
    s_cmp_eq_u32 s38, 1
    s_cbranch_scc0 L_c13
    s_waitcnt vmcnt(5)
    buffer_store_dwordx4 v[196:199], v253, s[24:27], s43 offen offset:256 sc1
L_c13:
    v_fma_f32 v51, v51, s39, v240
    v_exp_f32 v48, v48
    v_exp_f32 v49, v49
    v_cvt_pk_bf16_f32 v23, v46, v47
    v_fma_f32 v52, v52, s39, v240
    v_fma_f32 v53, v53, s39, v240
    v_exp_f32 v50, v50
    v_exp_f32 v51, v51
    v_cvt_pk_bf16_f32 v24, v48, v49
    v_fma_f32 v54, v54, s39, v240
    v_fma_f32 v55, v55, s39, v240
    v_exp_f32 v52, v52
    v_exp_f32 v53, v53
    v_cvt_pk_bf16_f32 v25, v50, v51
    s_cmp_eq_u32 s38, 1
    s_cbranch_scc0 L_c14
    s_waitcnt vmcnt(5)
    buffer_store_dwordx4 v[184:187], v253, s[24:27], s43 offen offset:3328 sc1
L_c14:
    v_fma_f32 v56, v56, s39, v241
    v_fma_f32 v57, v57, s39, v241
    v_exp_f32 v54, v54
    v_exp_f32 v55, v55
    v_cvt_pk_bf16_f32 v26, v52, v53
    v_fma_f32 v58, v58, s39, v241
    v_fma_f32 v59, v59, s39, v241
    v_exp_f32 v56, v56
    v_exp_f32 v57, v57
    v_cvt_pk_bf16_f32 v27, v54, v55
    v_fma_f32 v60, v60, s39, v241
    v_fma_f32 v61, v61, s39, v241
    v_exp_f32 v58, v58
    v_exp_f32 v59, v59
    v_cvt_pk_bf16_f32 v28, v56, v57
    s_cmp_ge_u32 s80, 2
    s_cbranch_scc1 L_tg15
L_tb15:
    s_barrier
    s_cmp_eq_u32 s38, 1
    s_cbranch_scc1 L_c16
    s_waitcnt vmcnt(5)
    buffer_load_dwordx4 v[144:147], v253, s[12:15], s42 offen offset:3072 nt
L_c16:
    v_fma_f32 v62, v62, s39, v241
    v_fma_f32 v63, v63, s39, v241
    v_exp_f32 v60, v60
    v_exp_f32 v61, v61
    v_cvt_pk_bf16_f32 v29, v58, v59
    v_fma_f32 v64, v64, s39, v240
    v_fma_f32 v65, v65, s39, v240
    v_exp_f32 v62, v62
    v_exp_f32 v63, v63
    v_cvt_pk_bf16_f32 v30, v60, v61
    v_fma_f32 v66, v66, s39, v240
    v_fma_f32 v67, v67, s39, v240
    v_exp_f32 v64, v64
    v_exp_f32 v65, v65
    s_cmp_eq_u32 s38, 1
    s_cbranch_scc1 L_c17
    s_waitcnt vmcnt(4)
L_c17:
    v_subrev_u32 v254, s77, v254
    s_mov_b64 exec, s[78:79]
    ds_write_b32 v247, v254
    s_mov_b64 exec, -1
    s_add_u32 s77, s77, 16
    v_cvt_pk_bf16_f32 v31, v62, v63
    v_fma_f32 v68, v68, s39, v240
    v_fma_f32 v69, v69, s39, v240
    v_exp_f32 v66, v66
    v_exp_f32 v67, v67
    v_cvt_pk_bf16_f32 v32, v64, v65
    v_fma_f32 v70, v70, s39, v240
    v_fma_f32 v71, v71, s39, v240
    v_exp_f32 v68, v68
    v_exp_f32 v69, v69
    v_cvt_pk_bf16_f32 v33, v66, v67
    v_fma_f32 v72, v72, s39, v241
    v_fma_f32 v73, v73, s39, v241
    v_exp_f32 v70, v70
    s_cmp_eq_u32 s38, 1
    s_cbranch_scc1 L_c18
    s_waitcnt vmcnt(5)
    buffer_load_dwordx4 v[148:151], v253, s[12:15], s35 offen offset:128 nt
L_c18:
    v_exp_f32 v71, v71
    v_cvt_pk_bf16_f32 v34, v68, v69
    v_fma_f32 v74, v74, s39, v241
    v_fma_f32 v75, v75, s39, v241
    v_exp_f32 v72, v72
    v_exp_f32 v73, v73
    v_cvt_pk_bf16_f32 v35, v70, v71
    v_fma_f32 v76, v76, s39, v241
    v_fma_f32 v77, v77, s39, v241
    v_exp_f32 v74, v74
    v_exp_f32 v75, v75
    v_cvt_pk_bf16_f32 v36, v72, v73
    v_fma_f32 v78, v78, s39, v241
    v_fma_f32 v79, v79, s39, v241
    s_waitcnt lgkmcnt(0)
    v_exp_f32 v76, v76
    v_exp_f32 v77, v77
    v_cvt_pk_bf16_f32 v37, v74, v75
    v_fma_f32 v80, v80, s39, v240
    v_fma_f32 v81, v81, s39, v240
    v_exp_f32 v78, v78
    v_exp_f32 v79, v79
    v_cvt_pk_bf16_f32 v38, v76, v77
    v_fma_f32 v82, v82, s39, v240
    v_fma_f32 v83, v83, s39, v240
    v_exp_f32 v80, v80
    v_exp_f32 v81, v81
    v_cvt_pk_bf16_f32 v39, v78, v79
    v_fma_f32 v84, v84, s39, v240
    s_cmp_eq_u32 s38, 1
    s_cbranch_scc1 L_c19
    s_waitcnt vmcnt(5)
    buffer_load_dwordx4 v[152:155], v253, s[12:15], s35 offen offset:3200 nt
L_c19:
    v_fma_f32 v85, v85, s39, v240
    v_exp_f32 v82, v82
    v_exp_f32 v83, v83
    v_cvt_pk_bf16_f32 v40, v80, v81
    v_fma_f32 v86, v86, s39, v240
    v_fma_f32 v87, v87, s39, v240
    v_exp_f32 v84, v84
    v_exp_f32 v85, v85
    v_cvt_pk_bf16_f32 v41, v82, v83
    v_fma_f32 v88, v88, s39, v241
    v_fma_f32 v89, v89, s39, v241
    v_exp_f32 v86, v86
    v_exp_f32 v87, v87
    v_cvt_pk_bf16_f32 v42, v84, v85
    s_cmp_eq_u32 s38, 1
    s_cbranch_scc0 L_c20
    s_waitcnt vmcnt(5)
    buffer_store_dwordx4 v[180:183], v253, s[24:27], s44 offen offset:256 sc1
L_c20:
    v_fma_f32 v90, v90, s39, v241
    v_fma_f32 v91, v91, s39, v241
    v_exp_f32 v88, v88
    v_exp_f32 v89, v89
    v_cvt_pk_bf16_f32 v43, v86, v87
    v_fma_f32 v92, v92, s39, v241
    v_fma_f32 v93, v93, s39, v241
    v_exp_f32 v90, v90
    v_exp_f32 v91, v91
    v_cvt_pk_bf16_f32 v44, v88, v89
    v_fma_f32 v94, v94, s39, v241
    v_fma_f32 v95, v95, s39, v241
    v_exp_f32 v92, v92
    v_exp_f32 v93, v93
    v_cvt_pk_bf16_f32 v45, v90, v91
    s_cmp_ge_u32 s80, 3
    s_cbranch_scc1 L_tg21
L_tb21:
    s_barrier
    ds_read_b32 v254, v247
    v_fma_f32 v96, v96, s39, v240
    v_fma_f32 v97, v97, s39, v240
    v_exp_f32 v94, v94
    v_exp_f32 v95, v95
    v_cvt_pk_bf16_f32 v46, v92, v93
    v_fma_f32 v98, v98, s39, v240
    v_fma_f32 v99, v99, s39, v240
    v_exp_f32 v96, v96
    v_exp_f32 v97, v97
    v_cvt_pk_bf16_f32 v47, v94, v95
    v_fma_f32 v100, v100, s39, v240
    v_fma_f32 v101, v101, s39, v240
    v_exp_f32 v98, v98
    v_exp_f32 v99, v99
    s_cmp_eq_u32 s38, 1
    s_cbranch_scc1 L_c22
    s_waitcnt vmcnt(5)
    buffer_load_dwordx4 v[156:159], v253, s[12:15], s42 offen offset:128 nt
L_c22:
    v_cvt_pk_bf16_f32 v48, v96, v97
    v_fma_f32 v102, v102, s39, v240
    v_fma_f32 v103, v103, s39, v240
    v_exp_f32 v100, v100
    v_exp_f32 v101, v101
    v_cvt_pk_bf16_f32 v49, v98, v99
    v_fma_f32 v104, v104, s39, v241
    v_fma_f32 v105, v105, s39, v241
    v_exp_f32 v102, v102
    v_exp_f32 v103, v103
    v_cvt_pk_bf16_f32 v50, v100, v101
    v_fma_f32 v106, v106, s39, v241
    v_fma_f32 v107, v107, s39, v241
    v_exp_f32 v104, v104
    s_waitcnt lgkmcnt(0)
    v_readfirstlane_b32 s81, v254
    s_cmp_lt_i32 s81, 10
    s_cselect_b32 s80, 1, 0
    s_cmp_lt_i32 s81, 6
    s_cselect_b32 s80, 2, s80
    s_cmp_lt_i32 s81, 3
    s_cselect_b32 s80, 3, s80
    s_cmp_eq_u32 s38, 1
    s_cselect_b32 s80, 0, s80
    s_cmp_le_u32 s38, 1
    s_cselect_b32 s81, 2, 9
    s_min_u32 s80, s80, s81
    s_cmp_le_u32 s38, 1
    s_cselect_b32 s81, 1, 9
    s_min_u32 s80, s80, s81
    v_exp_f32 v105, v105
    v_cvt_pk_bf16_f32 v51, v102, v103
    v_fma_f32 v108, v108, s39, v241
    v_fma_f32 v109, v109, s39, v241
    v_exp_f32 v106, v106
    v_exp_f32 v107, v107
    v_cvt_pk_bf16_f32 v52, v104, v105
    v_fma_f32 v110, v110, s39, v241
    v_fma_f32 v111, v111, s39, v241
    v_exp_f32 v108, v108
    v_exp_f32 v109, v109
    v_cvt_pk_bf16_f32 v53, v106, v107
    v_fma_f32 v112, v112, s39, v240
    v_fma_f32 v113, v113, s39, v240
    v_exp_f32 v110, v110
    s_cmp_eq_u32 s38, 1
    s_cbranch_scc1 L_c23
    s_waitcnt vmcnt(5)
    buffer_load_dwordx4 v[160:163], v253, s[12:15], s42 offen offset:3200 nt
L_c23:
    v_exp_f32 v111, v111
    v_cvt_pk_bf16_f32 v54, v108, v109
    v_fma_f32 v114, v114, s39, v240
    v_fma_f32 v115, v115, s39, v240
    v_exp_f32 v112, v112
    v_exp_f32 v113, v113
    v_cvt_pk_bf16_f32 v55, v110, v111
    v_fma_f32 v116, v116, s39, v240
    v_fma_f32 v117, v117, s39, v240
    v_exp_f32 v114, v114
    v_exp_f32 v115, v115
    v_cvt_pk_bf16_f32 v56, v112, v113
    v_fma_f32 v118, v118, s39, v240
    v_fma_f32 v119, v119, s39, v240
    s_cmp_eq_u32 s38, 1
    s_cbranch_scc1 L_c24
    s_waitcnt vmcnt(5)
    buffer_load_dwordx4 v[164:167], v253, s[12:15], s35 offen offset:256 nt
L_c24:
    v_exp_f32 v116, v116
    v_exp_f32 v117, v117
    v_cvt_pk_bf16_f32 v57, v114, v115
    v_fma_f32 v120, v120, s39, v241
    v_fma_f32 v121, v121, s39, v241
    v_exp_f32 v118, v118
    v_exp_f32 v119, v119
    v_cvt_pk_bf16_f32 v58, v116, v117
    v_fma_f32 v122, v122, s39, v241
    v_fma_f32 v123, v123, s39, v241
    v_exp_f32 v120, v120
    v_exp_f32 v121, v121
    v_cvt_pk_bf16_f32 v59, v118, v119
    v_fma_f32 v124, v124, s39, v241
    s_cmp_eq_u32 s38, 1
    s_cbranch_scc0 L_c25
    s_waitcnt vmcnt(5)
    buffer_store_dwordx4 v[192:195], v253, s[24:27], s44 offen offset:3328 sc1
L_c25:
    v_fma_f32 v125, v125, s39, v241
    v_exp_f32 v122, v122
    v_exp_f32 v123, v123
    v_cvt_pk_bf16_f32 v60, v120, v121
    v_fma_f32 v126, v126, s39, v241
    v_fma_f32 v127, v127, s39, v241
    v_exp_f32 v124, v124
    v_exp_f32 v125, v125
    v_cvt_pk_bf16_f32 v61, v122, v123
    v_exp_f32 v126, v126
    v_exp_f32 v127, v127
    v_add_u32 v249, s37, v248
    v_xor_b32 v250, 32, v249
    v_xor_b32 v251, 64, v249
    v_xor_b32 v252, 96, v249
    ds_read_b64_tr_b16 v[212:213], v249 offset:0
    ds_read_b64_tr_b16 v[214:215], v249 offset:6144
    ds_read_b64_tr_b16 v[216:217], v250 offset:0
    ds_read_b64_tr_b16 v[218:219], v250 offset:6144
    ds_read_b64_tr_b16 v[220:221], v251 offset:0
    ds_read_b64_tr_b16 v[222:223], v251 offset:6144
    ds_read_b64_tr_b16 v[224:225], v252 offset:0
    ds_read_b64_tr_b16 v[226:227], v252 offset:6144
    ds_read_b64_tr_b16 v[228:229], v249 offset:128
    ds_read_b64_tr_b16 v[230:231], v249 offset:6272
    s_add_u32 s37, s37, 24576
    s_cmp_eq_u32 s37, 147584
    s_cselect_b32 s37, 128, s37
    s_cselect_b32 s28, s29, 24576
    v_cvt_pk_bf16_f32 v62, v124, v125
    s_nop 0
    v_cvt_pk_bf16_f32 v63, v126, v127
    s_nop 1
    s_cmp_ge_u32 s80, 1
    s_cbranch_scc1 L_tg26
L_tb26:
    s_barrier
    s_waitcnt lgkmcnt(6)
    v_mfma_f32_16x16x32_bf16 v[64:67], v[212:215], v[0:3], 0
    s_cmp_eq_u32 s38, 1
    s_cbranch_scc1 L_c27
    s_waitcnt vmcnt(5)
    buffer_load_dwordx4 v[168:171], v253, s[12:15], s35 offen offset:3328 nt
L_c27:
    v_mfma_f32_16x16x32_bf16 v[80:83], v[212:215], v[4:7], 0
    ds_read_b64_tr_b16 v[212:213], v250 offset:128
    v_mfma_f32_16x16x32_bf16 v[68:71], v[216:219], v[0:3], 0
    ds_read_b64_tr_b16 v[214:215], v250 offset:6272
    v_mfma_f32_16x16x32_bf16 v[84:87], v[216:219], v[4:7], 0
    ds_read_b64_tr_b16 v[216:217], v251 offset:128
    s_waitcnt lgkmcnt(5)
    v_mfma_f32_16x16x32_bf16 v[72:75], v[220:223], v[0:3], 0
    ds_read_b64_tr_b16 v[218:219], v251 offset:6272
    v_mfma_f32_16x16x32_bf16 v[88:91], v[220:223], v[4:7], 0
    ds_read_b64_tr_b16 v[220:221], v252 offset:128
    v_mfma_f32_16x16x32_bf16 v[76:79], v[224:227], v[0:3], 0
    ds_read_b64_tr_b16 v[222:223], v252 offset:6272
    v_mfma_f32_16x16x32_bf16 v[92:95], v[224:227], v[4:7], 0
    v_mfma_f32_16x16x32_bf16 v[236:239], v[232:235], v[0:3], 0
    ds_read_b64_tr_b16 v[224:225], v249 offset:256
    s_waitcnt lgkmcnt(5)
    v_mfma_f32_16x16x32_bf16 v[96:99], v[228:231], v[0:3], 0
    ds_read_b64_tr_b16 v[226:227], v249 offset:6400
    v_mfma_f32_16x16x32_bf16 v[112:115], v[228:231], v[4:7], 0
    ds_read_b64_tr_b16 v[228:229], v250 offset:256
    v_mfma_f32_16x16x32_bf16 v[100:103], v[212:215], v[0:3], 0
    ds_read_b64_tr_b16 v[230:231], v250 offset:6400
    s_cmp_eq_u32 s38, 1
    s_cbranch_scc1 L_c28
    s_waitcnt vmcnt(5)
    buffer_load_dwordx4 v[172:175], v253, s[12:15], s42 offen offset:256 nt
L_c28:
    v_mfma_f32_16x16x32_bf16 v[116:119], v[212:215], v[4:7], 0
    ds_read_b64_tr_b16 v[212:213], v251 offset:256
    s_waitcnt lgkmcnt(5)
    v_mfma_f32_16x16x32_bf16 v[104:107], v[216:219], v[0:3], 0
    ds_read_b64_tr_b16 v[214:215], v251 offset:6400
    v_mfma_f32_16x16x32_bf16 v[120:123], v[216:219], v[4:7], 0
    ds_read_b64_tr_b16 v[216:217], v252 offset:256
    v_mfma_f32_16x16x32_bf16 v[108:111], v[220:223], v[0:3], 0
    ds_read_b64_tr_b16 v[218:219], v252 offset:6400
    v_mfma_f32_16x16x32_bf16 v[124:127], v[220:223], v[4:7], 0
    ds_read_b64_tr_b16 v[220:221], v249 offset:12288
    s_waitcnt lgkmcnt(5)
    v_mfma_f32_16x16x32_bf16 v[180:183], v[224:227], v[0:3], 0
    ds_read_b64_tr_b16 v[222:223], v249 offset:18432
    v_mfma_f32_16x16x32_bf16 v[196:199], v[224:227], v[4:7], 0
    v_mfma_f32_16x16x32_bf16 v[240:243], v[232:235], v[4:7], 0
    ds_read_b64_tr_b16 v[224:225], v250 offset:12288
    v_mfma_f32_16x16x32_bf16 v[184:187], v[228:231], v[0:3], 0
    ds_read_b64_tr_b16 v[226:227], v250 offset:18432
    v_mfma_f32_16x16x32_bf16 v[200:203], v[228:231], v[4:7], 0
    ds_read_b64_tr_b16 v[228:229], v251 offset:12288
    s_waitcnt lgkmcnt(5)
    v_mfma_f32_16x16x32_bf16 v[188:191], v[212:215], v[0:3], 0
    ds_read_b64_tr_b16 v[230:231], v251 offset:18432
    s_cmp_eq_u32 s38, 1
    s_cbranch_scc1 L_c29
    s_waitcnt vmcnt(5)
    buffer_load_dwordx4 v[176:179], v253, s[12:15], s42 offen offset:3328 nt
L_c29:
    v_mfma_f32_16x16x32_bf16 v[204:207], v[212:215], v[4:7], 0
    ds_read_b64_tr_b16 v[212:213], v252 offset:12288
    v_mfma_f32_16x16x32_bf16 v[192:195], v[216:219], v[0:3], 0
    ds_read_b64_tr_b16 v[214:215], v252 offset:18432
    v_mfma_f32_16x16x32_bf16 v[208:211], v[216:219], v[4:7], 0
    ds_read_b64_tr_b16 v[216:217], v249 offset:12416
    s_waitcnt lgkmcnt(5)
    v_mfma_f32_16x16x32_bf16 v[64:67], v[220:223], v[8:11], v[64:67]
    ds_read_b64_tr_b16 v[218:219], v249 offset:18560
    v_mfma_f32_16x16x32_bf16 v[80:83], v[220:223], v[12:15], v[80:83]
    ds_read_b64_tr_b16 v[220:221], v250 offset:12416
    v_mfma_f32_16x16x32_bf16 v[68:71], v[224:227], v[8:11], v[68:71]
    ds_read_b64_tr_b16 v[222:223], v250 offset:18560
    v_mfma_f32_16x16x32_bf16 v[84:87], v[224:227], v[12:15], v[84:87]
    ds_read_b64_tr_b16 v[224:225], v251 offset:12416
    s_waitcnt lgkmcnt(5)
    v_mfma_f32_16x16x32_bf16 v[72:75], v[228:231], v[8:11], v[72:75]
    ds_read_b64_tr_b16 v[226:227], v251 offset:18560
    v_mfma_f32_16x16x32_bf16 v[88:91], v[228:231], v[12:15], v[88:91]
    ds_read_b64_tr_b16 v[228:229], v252 offset:12416
    v_mfma_f32_16x16x32_bf16 v[76:79], v[212:215], v[8:11], v[76:79]
    ds_read_b64_tr_b16 v[230:231], v252 offset:18560
    v_mfma_f32_16x16x32_bf16 v[92:95], v[212:215], v[12:15], v[92:95]
    v_mfma_f32_16x16x32_bf16 v[236:239], v[232:235], v[8:11], v[236:239]
    ds_read_b64_tr_b16 v[212:213], v249 offset:12544
    s_waitcnt lgkmcnt(5)
    v_mfma_f32_16x16x32_bf16 v[96:99], v[216:219], v[8:11], v[96:99]
    ds_read_b64_tr_b16 v[214:215], v249 offset:18688
    v_mfma_f32_16x16x32_bf16 v[112:115], v[216:219], v[12:15], v[112:115]
    ds_read_b64_tr_b16 v[216:217], v250 offset:12544
    v_mfma_f32_16x16x32_bf16 v[100:103], v[220:223], v[8:11], v[100:103]
    ds_read_b64_tr_b16 v[218:219], v250 offset:18688
    v_add_u32 v249, s28, v249
    v_mfma_f32_16x16x32_bf16 v[116:119], v[220:223], v[12:15], v[116:119]
    ds_read_b64_tr_b16 v[220:221], v251 offset:12544
    s_waitcnt lgkmcnt(5)
    v_mfma_f32_16x16x32_bf16 v[104:107], v[224:227], v[8:11], v[104:107]
    ds_read_b64_tr_b16 v[222:223], v251 offset:18688
    v_add_u32 v250, s28, v250
    v_mfma_f32_16x16x32_bf16 v[120:123], v[224:227], v[12:15], v[120:123]
    s_cmp_eq_u32 s38, 1
    s_cbranch_scc0 L_c103
    s_waitcnt vmcnt(4)
L_c103:
    s_cmp_ge_u32 s80, 3
    s_cbranch_scc1 L_tg30
L_tb30:
    s_barrier
    ds_read_b64_tr_b16 v[224:225], v252 offset:12544
    v_mfma_f32_16x16x32_bf16 v[108:111], v[228:231], v[8:11], v[108:111]
    ds_read_b64_tr_b16 v[226:227], v252 offset:18688
    v_add_u32 v251, s28, v251
    v_mfma_f32_16x16x32_bf16 v[124:127], v[228:231], v[12:15], v[124:127]
    ds_read_b64_tr_b16 v[228:229], v249 offset:0
    s_waitcnt lgkmcnt(5)
    v_mfma_f32_16x16x32_bf16 v[180:183], v[212:215], v[8:11], v[180:183]
    ds_read_b64_tr_b16 v[230:231], v249 offset:6144
    v_add_u32 v252, s28, v252
    v_mfma_f32_16x16x32_bf16 v[196:199], v[212:215], v[12:15], v[196:199]
    s_cmp_eq_u32 s38, 1
    s_cbranch_scc1 L_c31
    v_mov_b32 v254, 1
    s_mov_b64 exec, s[78:79]
    buffer_atomic_add v254, off, s[72:75], s76 sc0 sc1
    s_mov_b64 exec, -1
L_c31:
    v_mfma_f32_16x16x32_bf16 v[240:243], v[232:235], v[12:15], v[240:243]
    ds_read_b64_tr_b16 v[212:213], v250 offset:0
    v_mfma_f32_16x16x32_bf16 v[184:187], v[216:219], v[8:11], v[184:187]
    ds_read_b64_tr_b16 v[214:215], v250 offset:6144
    s_add_u32 s37, s37, 24576
    v_mfma_f32_16x16x32_bf16 v[200:203], v[216:219], v[12:15], v[200:203]
    ds_read_b64_tr_b16 v[216:217], v251 offset:0
    s_waitcnt lgkmcnt(5)
    v_mfma_f32_16x16x32_bf16 v[188:191], v[220:223], v[8:11], v[188:191]
    ds_read_b64_tr_b16 v[218:219], v251 offset:6144
    s_cmp_eq_u32 s37, 147584
    v_mfma_f32_16x16x32_bf16 v[204:207], v[220:223], v[12:15], v[204:207]
    ds_read_b64_tr_b16 v[220:221], v252 offset:0
    s_cselect_b32 s37, 128, s37
    v_mfma_f32_16x16x32_bf16 v[192:195], v[224:227], v[8:11], v[192:195]
    ds_read_b64_tr_b16 v[222:223], v252 offset:6144
    s_cselect_b32 s28, s29, 24576
    v_mfma_f32_16x16x32_bf16 v[208:211], v[224:227], v[12:15], v[208:211]
    ds_read_b64_tr_b16 v[224:225], v249 offset:128
    s_waitcnt lgkmcnt(5)
    v_mfma_f32_16x16x32_bf16 v[64:67], v[228:231], v[16:19], v[64:67]
    ds_read_b64_tr_b16 v[226:227], v249 offset:6272
    v_mfma_f32_16x16x32_bf16 v[80:83], v[228:231], v[20:23], v[80:83]
    ds_read_b64_tr_b16 v[228:229], v250 offset:128
    v_mfma_f32_16x16x32_bf16 v[68:71], v[212:215], v[16:19], v[68:71]
    ds_read_b64_tr_b16 v[230:231], v250 offset:6272
    v_mfma_f32_16x16x32_bf16 v[84:87], v[212:215], v[20:23], v[84:87]
    ds_read_b64_tr_b16 v[212:213], v251 offset:128
    s_waitcnt lgkmcnt(5)
    v_mfma_f32_16x16x32_bf16 v[72:75], v[216:219], v[16:19], v[72:75]
    ds_read_b64_tr_b16 v[214:215], v251 offset:6272
    v_mfma_f32_16x16x32_bf16 v[88:91], v[216:219], v[20:23], v[88:91]
    ds_read_b64_tr_b16 v[216:217], v252 offset:128
    v_mfma_f32_16x16x32_bf16 v[76:79], v[220:223], v[16:19], v[76:79]
    ds_read_b64_tr_b16 v[218:219], v252 offset:6272
    v_mfma_f32_16x16x32_bf16 v[92:95], v[220:223], v[20:23], v[92:95]
    v_mfma_f32_16x16x32_bf16 v[236:239], v[232:235], v[16:19], v[236:239]
    ds_read_b64_tr_b16 v[220:221], v249 offset:256
    s_waitcnt lgkmcnt(5)
    v_mfma_f32_16x16x32_bf16 v[96:99], v[224:227], v[16:19], v[96:99]
    ds_read_b64_tr_b16 v[222:223], v249 offset:6400
    v_mfma_f32_16x16x32_bf16 v[112:115], v[224:227], v[20:23], v[112:115]
    ds_read_b64_tr_b16 v[224:225], v250 offset:256
    v_mfma_f32_16x16x32_bf16 v[100:103], v[228:231], v[16:19], v[100:103]
    ds_read_b64_tr_b16 v[226:227], v250 offset:6400
    s_cmp_eq_u32 s38, 1
    s_cbranch_scc1 L_c32
    s_mov_b32 m0, s36
    s_nop 0
    s_waitcnt vmcnt(5)
    buffer_load_dwordx4 v244, s[16:19], s35 offen nt lds
    s_waitcnt vmcnt(5)
    buffer_load_dwordx4 v245, s[16:19], s35 offen offset:1024 nt lds
    s_waitcnt vmcnt(5)
    buffer_load_dwordx4 v246, s[16:19], s35 offen offset:2048 nt lds
L_c32:
    v_mfma_f32_16x16x32_bf16 v[116:119], v[228:231], v[20:23], v[116:119]
    ds_read_b64_tr_b16 v[228:229], v251 offset:256
    s_waitcnt lgkmcnt(5)
    v_mfma_f32_16x16x32_bf16 v[104:107], v[212:215], v[16:19], v[104:107]
    ds_read_b64_tr_b16 v[230:231], v251 offset:6400
    v_mfma_f32_16x16x32_bf16 v[120:123], v[212:215], v[20:23], v[120:123]
    ds_read_b64_tr_b16 v[212:213], v252 offset:256
    v_mfma_f32_16x16x32_bf16 v[108:111], v[216:219], v[16:19], v[108:111]
    ds_read_b64_tr_b16 v[214:215], v252 offset:6400
    v_mfma_f32_16x16x32_bf16 v[124:127], v[216:219], v[20:23], v[124:127]
    ds_read_b64_tr_b16 v[216:217], v249 offset:12288
    s_waitcnt lgkmcnt(5)
    v_mfma_f32_16x16x32_bf16 v[180:183], v[220:223], v[16:19], v[180:183]
    ds_read_b64_tr_b16 v[218:219], v249 offset:18432
    v_mfma_f32_16x16x32_bf16 v[196:199], v[220:223], v[20:23], v[196:199]
    v_mfma_f32_16x16x32_bf16 v[240:243], v[232:235], v[20:23], v[240:243]
    ds_read_b64_tr_b16 v[220:221], v250 offset:12288
    v_mfma_f32_16x16x32_bf16 v[184:187], v[224:227], v[16:19], v[184:187]
    ds_read_b64_tr_b16 v[222:223], v250 offset:18432
    v_mfma_f32_16x16x32_bf16 v[200:203], v[224:227], v[20:23], v[200:203]
    ds_read_b64_tr_b16 v[224:225], v251 offset:12288
    s_waitcnt lgkmcnt(5)
    v_mfma_f32_16x16x32_bf16 v[188:191], v[228:231], v[16:19], v[188:191]
    ds_read_b64_tr_b16 v[226:227], v251 offset:18432
    v_mfma_f32_16x16x32_bf16 v[204:207], v[228:231], v[20:23], v[204:207]
    ds_read_b64_tr_b16 v[228:229], v252 offset:12288
    v_mfma_f32_16x16x32_bf16 v[192:195], v[212:215], v[16:19], v[192:195]
    ds_read_b64_tr_b16 v[230:231], v252 offset:18432
    v_mfma_f32_16x16x32_bf16 v[208:211], v[212:215], v[20:23], v[208:211]
    ds_read_b64_tr_b16 v[212:213], v249 offset:12416
    s_waitcnt lgkmcnt(5)
    v_mfma_f32_16x16x32_bf16 v[64:67], v[216:219], v[24:27], v[64:67]
    ds_read_b64_tr_b16 v[214:215], v249 offset:18560
    v_mfma_f32_16x16x32_bf16 v[80:83], v[216:219], v[28:31], v[80:83]
    ds_read_b64_tr_b16 v[216:217], v250 offset:12416
    v_mfma_f32_16x16x32_bf16 v[68:71], v[220:223], v[24:27], v[68:71]
    ds_read_b64_tr_b16 v[218:219], v250 offset:18560
    v_mfma_f32_16x16x32_bf16 v[84:87], v[220:223], v[28:31], v[84:87]
    ds_read_b64_tr_b16 v[220:221], v251 offset:12416
    s_waitcnt lgkmcnt(5)
    v_mfma_f32_16x16x32_bf16 v[72:75], v[224:227], v[24:27], v[72:75]
    ds_read_b64_tr_b16 v[222:223], v251 offset:18560
    v_mfma_f32_16x16x32_bf16 v[88:91], v[224:227], v[28:31], v[88:91]
    ds_read_b64_tr_b16 v[224:225], v252 offset:12416
    v_mfma_f32_16x16x32_bf16 v[76:79], v[228:231], v[24:27], v[76:79]
    ds_read_b64_tr_b16 v[226:227], v252 offset:18560
    v_mfma_f32_16x16x32_bf16 v[92:95], v[228:231], v[28:31], v[92:95]
    v_mfma_f32_16x16x32_bf16 v[236:239], v[232:235], v[24:27], v[236:239]
    ds_read_b64_tr_b16 v[228:229], v249 offset:12544
    s_waitcnt lgkmcnt(5)
    v_mfma_f32_16x16x32_bf16 v[96:99], v[212:215], v[24:27], v[96:99]
    ds_read_b64_tr_b16 v[230:231], v249 offset:18688
    v_mfma_f32_16x16x32_bf16 v[112:115], v[212:215], v[28:31], v[112:115]
    ds_read_b64_tr_b16 v[212:213], v250 offset:12544
    v_mfma_f32_16x16x32_bf16 v[100:103], v[216:219], v[24:27], v[100:103]
    ds_read_b64_tr_b16 v[214:215], v250 offset:18688
    v_add_u32 v249, s28, v249
    v_mfma_f32_16x16x32_bf16 v[116:119], v[216:219], v[28:31], v[116:119]
    ds_read_b64_tr_b16 v[216:217], v251 offset:12544
    s_waitcnt lgkmcnt(5)
    v_mfma_f32_16x16x32_bf16 v[104:107], v[220:223], v[24:27], v[104:107]
    ds_read_b64_tr_b16 v[218:219], v251 offset:18688
    v_add_u32 v250, s28, v250
    v_mfma_f32_16x16x32_bf16 v[120:123], v[220:223], v[28:31], v[120:123]
    s_cmp_ge_u32 s80, 2
    s_cbranch_scc1 L_tg33
L_tb33:
    s_barrier
    ds_read_b64_tr_b16 v[220:221], v252 offset:12544
    v_mfma_f32_16x16x32_bf16 v[108:111], v[224:227], v[24:27], v[108:111]
    ds_read_b64_tr_b16 v[222:223], v252 offset:18688
    v_add_u32 v251, s28, v251
    v_mfma_f32_16x16x32_bf16 v[124:127], v[224:227], v[28:31], v[124:127]
    ds_read_b64_tr_b16 v[224:225], v249 offset:0
    s_waitcnt lgkmcnt(5)
    v_mfma_f32_16x16x32_bf16 v[180:183], v[228:231], v[24:27], v[180:183]
    ds_read_b64_tr_b16 v[226:227], v249 offset:6144
    v_add_u32 v252, s28, v252
    v_mfma_f32_16x16x32_bf16 v[196:199], v[228:231], v[28:31], v[196:199]
    s_cmp_eq_u32 s38, 1
    s_cbranch_scc1 L_c34
    s_add_u32 m0, s36, 12288
    s_add_u32 s41, s35, 12288
    s_waitcnt vmcnt(5)
    buffer_load_dwordx4 v244, s[16:19], s41 offen nt lds
    s_waitcnt vmcnt(5)
    buffer_load_dwordx4 v245, s[16:19], s41 offen offset:1024 nt lds
    s_waitcnt vmcnt(5)
    buffer_load_dwordx4 v246, s[16:19], s41 offen offset:2048 nt lds
    s_add_u32 s36, s36, 24576
    s_cmp_eq_u32 s36, s45
    s_cselect_b32 s36, s33, s36
L_c34:
    v_mfma_f32_16x16x32_bf16 v[240:243], v[232:235], v[28:31], v[240:243]
    ds_read_b64_tr_b16 v[228:229], v250 offset:0
    v_mfma_f32_16x16x32_bf16 v[184:187], v[212:215], v[24:27], v[184:187]
    ds_read_b64_tr_b16 v[230:231], v250 offset:6144
    s_add_u32 s37, s37, 24576
    v_mfma_f32_16x16x32_bf16 v[200:203], v[212:215], v[28:31], v[200:203]
    ds_read_b64_tr_b16 v[212:213], v251 offset:0
    s_waitcnt lgkmcnt(5)
    v_mfma_f32_16x16x32_bf16 v[188:191], v[216:219], v[24:27], v[188:191]
    ds_read_b64_tr_b16 v[214:215], v251 offset:6144
    s_cmp_eq_u32 s37, 147584
    v_mfma_f32_16x16x32_bf16 v[204:207], v[216:219], v[28:31], v[204:207]
    ds_read_b64_tr_b16 v[216:217], v252 offset:0
    s_cselect_b32 s37, 128, s37
    v_mfma_f32_16x16x32_bf16 v[192:195], v[220:223], v[24:27], v[192:195]
    ds_read_b64_tr_b16 v[218:219], v252 offset:6144
    s_cselect_b32 s28, s29, 24576
    v_mfma_f32_16x16x32_bf16 v[208:211], v[220:223], v[28:31], v[208:211]
    ds_read_b64_tr_b16 v[220:221], v249 offset:128
    s_waitcnt lgkmcnt(5)
    v_mfma_f32_16x16x32_bf16 v[64:67], v[224:227], v[32:35], v[64:67]
    ds_read_b64_tr_b16 v[222:223], v249 offset:6272
    v_mfma_f32_16x16x32_bf16 v[80:83], v[224:227], v[36:39], v[80:83]
    ds_read_b64_tr_b16 v[224:225], v250 offset:128
    v_mfma_f32_16x16x32_bf16 v[68:71], v[228:231], v[32:35], v[68:71]
    ds_read_b64_tr_b16 v[226:227], v250 offset:6272
    v_mfma_f32_16x16x32_bf16 v[84:87], v[228:231], v[36:39], v[84:87]
    ds_read_b64_tr_b16 v[228:229], v251 offset:128
    s_waitcnt lgkmcnt(5)
    v_mfma_f32_16x16x32_bf16 v[72:75], v[212:215], v[32:35], v[72:75]
    ds_read_b64_tr_b16 v[230:231], v251 offset:6272
    s_cmp_eq_u32 s38, 1
    s_cbranch_scc1 L_c35
L_c35:
    v_subrev_u32 v254, s77, v254
    s_mov_b64 exec, s[78:79]
    ds_write_b32 v247, v254
    s_mov_b64 exec, -1
    s_add_u32 s77, s77, 16
    v_mfma_f32_16x16x32_bf16 v[88:91], v[212:215], v[36:39], v[88:91]
    ds_read_b64_tr_b16 v[212:213], v252 offset:128
    v_mfma_f32_16x16x32_bf16 v[76:79], v[216:219], v[32:35], v[76:79]
    ds_read_b64_tr_b16 v[214:215], v252 offset:6272
    v_mfma_f32_16x16x32_bf16 v[92:95], v[216:219], v[36:39], v[92:95]
    v_mfma_f32_16x16x32_bf16 v[236:239], v[232:235], v[32:35], v[236:239]
    ds_read_b64_tr_b16 v[216:217], v249 offset:256
    s_waitcnt lgkmcnt(6)
    v_mfma_f32_16x16x32_bf16 v[96:99], v[220:223], v[32:35], v[96:99]
    ds_read_b64_tr_b16 v[218:219], v249 offset:6400
    v_mfma_f32_16x16x32_bf16 v[112:115], v[220:223], v[36:39], v[112:115]
    ds_read_b64_tr_b16 v[220:221], v250 offset:256
    v_mfma_f32_16x16x32_bf16 v[100:103], v[224:227], v[32:35], v[100:103]
    ds_read_b64_tr_b16 v[222:223], v250 offset:6400
    v_mfma_f32_16x16x32_bf16 v[116:119], v[224:227], v[36:39], v[116:119]
    ds_read_b64_tr_b16 v[224:225], v251 offset:256
    s_waitcnt lgkmcnt(5)
    v_mfma_f32_16x16x32_bf16 v[104:107], v[228:231], v[32:35], v[104:107]
    ds_read_b64_tr_b16 v[226:227], v251 offset:6400
    v_mfma_f32_16x16x32_bf16 v[120:123], v[228:231], v[36:39], v[120:123]
    ds_read_b64_tr_b16 v[228:229], v252 offset:256
    v_mfma_f32_16x16x32_bf16 v[108:111], v[212:215], v[32:35], v[108:111]
    ds_read_b64_tr_b16 v[230:231], v252 offset:6400
    v_mfma_f32_16x16x32_bf16 v[124:127], v[212:215], v[36:39], v[124:127]
    ds_read_b64_tr_b16 v[212:213], v249 offset:12288
    s_waitcnt lgkmcnt(5)
    v_mfma_f32_16x16x32_bf16 v[180:183], v[216:219], v[32:35], v[180:183]
    ds_read_b64_tr_b16 v[214:215], v249 offset:18432
    v_mfma_f32_16x16x32_bf16 v[196:199], v[216:219], v[36:39], v[196:199]
    v_mfma_f32_16x16x32_bf16 v[240:243], v[232:235], v[36:39], v[240:243]
    ds_read_b64_tr_b16 v[216:217], v250 offset:12288
    v_mfma_f32_16x16x32_bf16 v[184:187], v[220:223], v[32:35], v[184:187]
    ds_read_b64_tr_b16 v[218:219], v250 offset:18432
    v_mfma_f32_16x16x32_bf16 v[200:203], v[220:223], v[36:39], v[200:203]
    ds_read_b64_tr_b16 v[220:221], v251 offset:12288
    s_waitcnt lgkmcnt(5)
    v_mfma_f32_16x16x32_bf16 v[188:191], v[224:227], v[32:35], v[188:191]
    ds_read_b64_tr_b16 v[222:223], v251 offset:18432
    v_mfma_f32_16x16x32_bf16 v[204:207], v[224:227], v[36:39], v[204:207]
    ds_read_b64_tr_b16 v[224:225], v252 offset:12288
    v_mfma_f32_16x16x32_bf16 v[192:195], v[228:231], v[32:35], v[192:195]
    ds_read_b64_tr_b16 v[226:227], v252 offset:18432
    v_mfma_f32_16x16x32_bf16 v[208:211], v[228:231], v[36:39], v[208:211]
    ds_read_b64_tr_b16 v[228:229], v249 offset:12416
    s_waitcnt lgkmcnt(5)
    v_mfma_f32_16x16x32_bf16 v[64:67], v[212:215], v[40:43], v[64:67]
    ds_read_b64_tr_b16 v[230:231], v249 offset:18560
    v_mfma_f32_16x16x32_bf16 v[80:83], v[212:215], v[44:47], v[80:83]
    ds_read_b64_tr_b16 v[212:213], v250 offset:12416
    v_mfma_f32_16x16x32_bf16 v[68:71], v[216:219], v[40:43], v[68:71]
    ds_read_b64_tr_b16 v[214:215], v250 offset:18560
    v_mfma_f32_16x16x32_bf16 v[84:87], v[216:219], v[44:47], v[84:87]
    ds_read_b64_tr_b16 v[216:217], v251 offset:12416
    s_waitcnt lgkmcnt(5)
    v_mfma_f32_16x16x32_bf16 v[72:75], v[220:223], v[40:43], v[72:75]
    ds_read_b64_tr_b16 v[218:219], v251 offset:18560
    v_mfma_f32_16x16x32_bf16 v[88:91], v[220:223], v[44:47], v[88:91]
    ds_read_b64_tr_b16 v[220:221], v252 offset:12416
    v_mfma_f32_16x16x32_bf16 v[76:79], v[224:227], v[40:43], v[76:79]
    ds_read_b64_tr_b16 v[222:223], v252 offset:18560
    v_mfma_f32_16x16x32_bf16 v[92:95], v[224:227], v[44:47], v[92:95]
    v_mfma_f32_16x16x32_bf16 v[236:239], v[232:235], v[40:43], v[236:239]
    ds_read_b64_tr_b16 v[224:225], v249 offset:12544
    s_waitcnt lgkmcnt(5)
    v_mfma_f32_16x16x32_bf16 v[96:99], v[228:231], v[40:43], v[96:99]
    ds_read_b64_tr_b16 v[226:227], v249 offset:18688
    v_mfma_f32_16x16x32_bf16 v[112:115], v[228:231], v[44:47], v[112:115]
    ds_read_b64_tr_b16 v[228:229], v250 offset:12544
    v_mfma_f32_16x16x32_bf16 v[100:103], v[212:215], v[40:43], v[100:103]
    ds_read_b64_tr_b16 v[230:231], v250 offset:18688
    v_add_u32 v249, s28, v249
    v_mfma_f32_16x16x32_bf16 v[116:119], v[212:215], v[44:47], v[116:119]
    ds_read_b64_tr_b16 v[212:213], v251 offset:12544
    s_waitcnt lgkmcnt(5)
    v_mfma_f32_16x16x32_bf16 v[104:107], v[216:219], v[40:43], v[104:107]
    ds_read_b64_tr_b16 v[214:215], v251 offset:18688
    v_add_u32 v250, s28, v250
    v_mfma_f32_16x16x32_bf16 v[120:123], v[216:219], v[44:47], v[120:123]
    s_cmp_ge_u32 s80, 3
    s_cbranch_scc1 L_tg36
L_tb36:
    s_barrier
    ds_read_b64_tr_b16 v[216:217], v252 offset:12544
    v_mfma_f32_16x16x32_bf16 v[108:111], v[220:223], v[40:43], v[108:111]
    ds_read_b64_tr_b16 v[218:219], v252 offset:18688
    v_add_u32 v251, s28, v251
    v_mfma_f32_16x16x32_bf16 v[124:127], v[220:223], v[44:47], v[124:127]
    ds_read_b64_tr_b16 v[220:221], v249 offset:0
    s_waitcnt lgkmcnt(5)
    v_mfma_f32_16x16x32_bf16 v[180:183], v[224:227], v[40:43], v[180:183]
    ds_read_b64_tr_b16 v[222:223], v249 offset:6144
    v_add_u32 v252, s28, v252
    v_mfma_f32_16x16x32_bf16 v[196:199], v[224:227], v[44:47], v[196:199]
    ds_read_b32 v254, v247
    v_mfma_f32_16x16x32_bf16 v[240:243], v[232:235], v[44:47], v[240:243]
    ds_read_b64_tr_b16 v[224:225], v250 offset:0
    v_mfma_f32_16x16x32_bf16 v[184:187], v[228:231], v[40:43], v[184:187]
    ds_read_b64_tr_b16 v[226:227], v250 offset:6144
    s_add_u32 s37, s37, 24576
    v_mfma_f32_16x16x32_bf16 v[200:203], v[228:231], v[44:47], v[200:203]
    ds_read_b64_tr_b16 v[228:229], v251 offset:0
    s_waitcnt lgkmcnt(6)
    v_mfma_f32_16x16x32_bf16 v[188:191], v[212:215], v[40:43], v[188:191]
    ds_read_b64_tr_b16 v[230:231], v251 offset:6144
    s_cmp_eq_u32 s37, 147584
    v_mfma_f32_16x16x32_bf16 v[204:207], v[212:215], v[44:47], v[204:207]
    ds_read_b64_tr_b16 v[212:213], v252 offset:0
    s_cselect_b32 s37, 128, s37
    v_mfma_f32_16x16x32_bf16 v[192:195], v[216:219], v[40:43], v[192:195]
    ds_read_b64_tr_b16 v[214:215], v252 offset:6144
    s_cselect_b32 s28, s29, 24576
    v_mfma_f32_16x16x32_bf16 v[208:211], v[216:219], v[44:47], v[208:211]
    ds_read_b64_tr_b16 v[216:217], v249 offset:128
    s_waitcnt lgkmcnt(5)
    v_mfma_f32_16x16x32_bf16 v[64:67], v[220:223], v[48:51], v[64:67]
    ds_read_b64_tr_b16 v[218:219], v249 offset:6272
    v_mfma_f32_16x16x32_bf16 v[80:83], v[220:223], v[52:55], v[80:83]
    ds_read_b64_tr_b16 v[220:221], v250 offset:128
    v_mfma_f32_16x16x32_bf16 v[68:71], v[224:227], v[48:51], v[68:71]
    ds_read_b64_tr_b16 v[222:223], v250 offset:6272
    v_mfma_f32_16x16x32_bf16 v[84:87], v[224:227], v[52:55], v[84:87]
    ds_read_b64_tr_b16 v[224:225], v251 offset:128
    s_waitcnt lgkmcnt(5)
    v_mfma_f32_16x16x32_bf16 v[72:75], v[228:231], v[48:51], v[72:75]
    ds_read_b64_tr_b16 v[226:227], v251 offset:6272
    v_mfma_f32_16x16x32_bf16 v[88:91], v[228:231], v[52:55], v[88:91]
    ds_read_b64_tr_b16 v[228:229], v252 offset:128
    v_mfma_f32_16x16x32_bf16 v[76:79], v[212:215], v[48:51], v[76:79]
    ds_read_b64_tr_b16 v[230:231], v252 offset:6272
    s_cmp_eq_u32 s38, 1
    s_cbranch_scc1 L_c37
    s_mov_b32 m0, s36
    s_add_u32 s41, s35, 24576
    s_waitcnt vmcnt(5)
    buffer_load_dwordx4 v244, s[16:19], s41 offen nt lds
    s_waitcnt vmcnt(5)
    buffer_load_dwordx4 v245, s[16:19], s41 offen offset:1024 nt lds
    s_waitcnt vmcnt(5)
    buffer_load_dwordx4 v246, s[16:19], s41 offen offset:2048 nt lds
L_c37:
    v_mfma_f32_16x16x32_bf16 v[92:95], v[212:215], v[52:55], v[92:95]
    v_mfma_f32_16x16x32_bf16 v[236:239], v[232:235], v[48:51], v[236:239]
    ds_read_b64_tr_b16 v[212:213], v249 offset:256
    s_waitcnt lgkmcnt(5)
    v_mfma_f32_16x16x32_bf16 v[96:99], v[216:219], v[48:51], v[96:99]
    ds_read_b64_tr_b16 v[214:215], v249 offset:6400
    v_mfma_f32_16x16x32_bf16 v[112:115], v[216:219], v[52:55], v[112:115]
    ds_read_b64_tr_b16 v[216:217], v250 offset:256
    v_mfma_f32_16x16x32_bf16 v[100:103], v[220:223], v[48:51], v[100:103]
    ds_read_b64_tr_b16 v[218:219], v250 offset:6400
    v_mfma_f32_16x16x32_bf16 v[116:119], v[220:223], v[52:55], v[116:119]
    ds_read_b64_tr_b16 v[220:221], v251 offset:256
    s_waitcnt lgkmcnt(5)
    v_mfma_f32_16x16x32_bf16 v[104:107], v[224:227], v[48:51], v[104:107]
    ds_read_b64_tr_b16 v[222:223], v251 offset:6400
    v_mfma_f32_16x16x32_bf16 v[120:123], v[224:227], v[52:55], v[120:123]
    ds_read_b64_tr_b16 v[224:225], v252 offset:256
    v_mfma_f32_16x16x32_bf16 v[108:111], v[228:231], v[48:51], v[108:111]
    ds_read_b64_tr_b16 v[226:227], v252 offset:6400
    v_mfma_f32_16x16x32_bf16 v[124:127], v[228:231], v[52:55], v[124:127]
    ds_read_b64_tr_b16 v[228:229], v249 offset:12288
    s_waitcnt lgkmcnt(5)
    v_mfma_f32_16x16x32_bf16 v[180:183], v[212:215], v[48:51], v[180:183]
    ds_read_b64_tr_b16 v[230:231], v249 offset:18432
    v_mfma_f32_16x16x32_bf16 v[196:199], v[212:215], v[52:55], v[196:199]
    v_mfma_f32_16x16x32_bf16 v[240:243], v[232:235], v[52:55], v[240:243]
    ds_read_b64_tr_b16 v[212:213], v250 offset:12288
    v_mfma_f32_16x16x32_bf16 v[184:187], v[216:219], v[48:51], v[184:187]
    ds_read_b64_tr_b16 v[214:215], v250 offset:18432
    v_mfma_f32_16x16x32_bf16 v[200:203], v[216:219], v[52:55], v[200:203]
    ds_read_b64_tr_b16 v[216:217], v251 offset:12288
    s_waitcnt lgkmcnt(5)
    v_mfma_f32_16x16x32_bf16 v[188:191], v[220:223], v[48:51], v[188:191]
    ds_read_b64_tr_b16 v[218:219], v251 offset:18432
    v_mfma_f32_16x16x32_bf16 v[204:207], v[220:223], v[52:55], v[204:207]
    ds_read_b64_tr_b16 v[220:221], v252 offset:12288
    v_mfma_f32_16x16x32_bf16 v[192:195], v[224:227], v[48:51], v[192:195]
    ds_read_b64_tr_b16 v[222:223], v252 offset:18432
    v_mfma_f32_16x16x32_bf16 v[208:211], v[224:227], v[52:55], v[208:211]
    ds_read_b64_tr_b16 v[224:225], v249 offset:12416
    s_waitcnt lgkmcnt(5)
    v_mfma_f32_16x16x32_bf16 v[64:67], v[228:231], v[56:59], v[64:67]
    ds_read_b64_tr_b16 v[226:227], v249 offset:18560
    v_mfma_f32_16x16x32_bf16 v[80:83], v[228:231], v[60:63], v[80:83]
    ds_read_b64_tr_b16 v[228:229], v250 offset:12416
    v_readfirstlane_b32 s81, v254
    v_mfma_f32_16x16x32_bf16 v[68:71], v[212:215], v[56:59], v[68:71]
    ds_read_b64_tr_b16 v[230:231], v250 offset:18560
    s_cmp_lt_i32 s81, 10
    v_mfma_f32_16x16x32_bf16 v[84:87], v[212:215], v[60:63], v[84:87]
    ds_read_b64_tr_b16 v[212:213], v251 offset:12416
    s_waitcnt lgkmcnt(5)
    v_mfma_f32_16x16x32_bf16 v[72:75], v[216:219], v[56:59], v[72:75]
    ds_read_b64_tr_b16 v[214:215], v251 offset:18560
    s_cselect_b32 s80, 1, 0
    v_mfma_f32_16x16x32_bf16 v[88:91], v[216:219], v[60:63], v[88:91]
    ds_read_b64_tr_b16 v[216:217], v252 offset:12416
    s_cmp_lt_i32 s81, 6
    v_mfma_f32_16x16x32_bf16 v[76:79], v[220:223], v[56:59], v[76:79]
    ds_read_b64_tr_b16 v[218:219], v252 offset:18560
    s_cselect_b32 s80, 2, s80
    v_mfma_f32_16x16x32_bf16 v[92:95], v[220:223], v[60:63], v[92:95]
    s_cmp_lt_i32 s81, 3
    s_cselect_b32 s80, 3, s80
    v_mfma_f32_16x16x32_bf16 v[236:239], v[232:235], v[56:59], v[236:239]
    ds_read_b64_tr_b16 v[220:221], v249 offset:12544
    s_waitcnt lgkmcnt(5)
    v_mfma_f32_16x16x32_bf16 v[96:99], v[224:227], v[56:59], v[96:99]
    ds_read_b64_tr_b16 v[222:223], v249 offset:18688
    s_cmp_eq_u32 s38, 1
    v_mfma_f32_16x16x32_bf16 v[112:115], v[224:227], v[60:63], v[112:115]
    ds_read_b64_tr_b16 v[224:225], v250 offset:12544
    s_cselect_b32 s80, 0, s80
    v_mfma_f32_16x16x32_bf16 v[100:103], v[228:231], v[56:59], v[100:103]
    ds_read_b64_tr_b16 v[226:227], v250 offset:18688
    s_cmp_le_u32 s38, 1
    v_mfma_f32_16x16x32_bf16 v[116:119], v[228:231], v[60:63], v[116:119]
    ds_read_b64_tr_b16 v[228:229], v251 offset:12544
    s_waitcnt lgkmcnt(5)
    v_mfma_f32_16x16x32_bf16 v[104:107], v[212:215], v[56:59], v[104:107]
    ds_read_b64_tr_b16 v[230:231], v251 offset:18688
    s_cselect_b32 s81, 2, 9
    v_mfma_f32_16x16x32_bf16 v[120:123], v[212:215], v[60:63], v[120:123]
    ds_read_b64_tr_b16 v[212:213], v252 offset:12544
    s_min_u32 s80, s80, s81
    v_mfma_f32_16x16x32_bf16 v[108:111], v[216:219], v[56:59], v[108:111]
    ds_read_b64_tr_b16 v[214:215], v252 offset:18688
    s_cmp_le_u32 s38, 1
    v_mfma_f32_16x16x32_bf16 v[124:127], v[216:219], v[60:63], v[124:127]
    s_cselect_b32 s81, 1, 9
    s_waitcnt lgkmcnt(4)
    v_mfma_f32_16x16x32_bf16 v[180:183], v[220:223], v[56:59], v[180:183]
    s_min_u32 s80, s80, s81
    v_mfma_f32_16x16x32_bf16 v[196:199], v[220:223], v[60:63], v[196:199]
    v_mfma_f32_16x16x32_bf16 v[240:243], v[232:235], v[60:63], v[240:243]
    v_mfma_f32_16x16x32_bf16 v[184:187], v[224:227], v[56:59], v[184:187]
    v_mfma_f32_16x16x32_bf16 v[200:203], v[224:227], v[60:63], v[200:203]
    s_waitcnt lgkmcnt(0)
    v_mfma_f32_16x16x32_bf16 v[188:191], v[228:231], v[56:59], v[188:191]
    v_mfma_f32_16x16x32_bf16 v[204:207], v[228:231], v[60:63], v[204:207]
    v_mfma_f32_16x16x32_bf16 v[192:195], v[212:215], v[56:59], v[192:195]
    v_mfma_f32_16x16x32_bf16 v[208:211], v[212:215], v[60:63], v[208:211]
    s_cmp_ge_u32 s80, 1
    s_cbranch_scc1 L_tg38
L_tb38:
    s_barrier
    s_mov_b32 s43, s34
    s_add_u32 s44, s34, 6144
    s_mov_b32 s26, 100663296
    s_nop 3
    s_nop 3
    v_rcp_f32 v236, v236
    v_rcp_f32 v240, v240
    s_cmp_eq_u32 s38, 1
    s_cbranch_scc1 L_c39
    s_add_u32 m0, s36, 12288
    s_add_u32 s41, s35, 36864
    s_waitcnt vmcnt(5)
    buffer_load_dwordx4 v244, s[16:19], s41 offen nt lds
    s_waitcnt vmcnt(5)
    buffer_load_dwordx4 v245, s[16:19], s41 offen offset:1024 nt lds
    s_waitcnt vmcnt(5)
    buffer_load_dwordx4 v246, s[16:19], s41 offen offset:2048 nt lds
    s_add_u32 s36, s36, 73728
    s_cmp_ge_u32 s36, s45
    s_cselect_b32 s41, 147456, 0
    s_sub_u32 s36, s36, s41
L_c39:
    v_mul_f32 v64, v64, v236
    v_mul_f32 v65, v65, v236
    v_mul_f32 v66, v66, v236
    v_mul_f32 v67, v67, v236
    v_mul_f32 v68, v68, v236
    v_mul_f32 v69, v69, v236
    v_mul_f32 v70, v70, v236
    v_mul_f32 v71, v71, v236
    v_cvt_pk_bf16_f32 v64, v64, v65
    v_cvt_pk_bf16_f32 v65, v66, v67
    v_cvt_pk_bf16_f32 v66, v68, v69
    v_cvt_pk_bf16_f32 v67, v70, v71
    v_mul_f32 v72, v72, v236
    v_mul_f32 v73, v73, v236
    v_mul_f32 v74, v74, v236
    v_mul_f32 v75, v75, v236
    v_mul_f32 v76, v76, v236
    v_mul_f32 v77, v77, v236
    v_mul_f32 v78, v78, v236
    v_mul_f32 v79, v79, v236
    v_cvt_pk_bf16_f32 v68, v72, v73
    v_cvt_pk_bf16_f32 v69, v74, v75
    v_cvt_pk_bf16_f32 v70, v76, v77
    v_cvt_pk_bf16_f32 v71, v78, v79
    v_mul_f32 v80, v80, v240
    v_mul_f32 v81, v81, v240
    v_mul_f32 v82, v82, v240
    v_mul_f32 v83, v83, v240
    v_mul_f32 v84, v84, v240
    v_mul_f32 v85, v85, v240
    v_mul_f32 v86, v86, v240
    v_mul_f32 v87, v87, v240
    v_cvt_pk_bf16_f32 v72, v80, v81
    v_cvt_pk_bf16_f32 v73, v82, v83
    v_cvt_pk_bf16_f32 v74, v84, v85
    v_cvt_pk_bf16_f32 v75, v86, v87
    v_mul_f32 v88, v88, v240
    v_mul_f32 v89, v89, v240
    v_mul_f32 v90, v90, v240
    v_mul_f32 v91, v91, v240
    v_mul_f32 v92, v92, v240
    v_mul_f32 v93, v93, v240
    v_mul_f32 v94, v94, v240
    v_mul_f32 v95, v95, v240
    v_cvt_pk_bf16_f32 v76, v88, v89
    v_cvt_pk_bf16_f32 v77, v90, v91
    v_cvt_pk_bf16_f32 v78, v92, v93
    v_cvt_pk_bf16_f32 v79, v94, v95
    v_cndmask_b32_dpp v80, v68, v64, vcc row_ror:8 row_mask:0xf bank_mask:0xf
    v_cndmask_b32_dpp v81, v69, v65, vcc row_ror:8 row_mask:0xf bank_mask:0xf
    v_cndmask_b32_dpp v82, v70, v66, vcc row_ror:8 row_mask:0xf bank_mask:0xf
    v_cndmask_b32_dpp v83, v71, v67, vcc row_ror:8 row_mask:0xf bank_mask:0xf
    v_mov_b32_dpp v68, v64 row_ror:8 row_mask:0xf bank_mask:0x3
    v_mov_b32_dpp v69, v65 row_ror:8 row_mask:0xf bank_mask:0x3
    v_mov_b32_dpp v70, v66 row_ror:8 row_mask:0xf bank_mask:0x3
    v_mov_b32_dpp v71, v67 row_ror:8 row_mask:0xf bank_mask:0x3
    v_cndmask_b32_dpp v64, v76, v72, vcc row_ror:8 row_mask:0xf bank_mask:0xf
    v_cndmask_b32_dpp v65, v77, v73, vcc row_ror:8 row_mask:0xf bank_mask:0xf
    v_cndmask_b32_dpp v66, v78, v74, vcc row_ror:8 row_mask:0xf bank_mask:0xf
    v_cndmask_b32_dpp v67, v79, v75, vcc row_ror:8 row_mask:0xf bank_mask:0xf
    v_mov_b32_dpp v76, v72 row_ror:8 row_mask:0xf bank_mask:0x3
    v_mov_b32_dpp v77, v73 row_ror:8 row_mask:0xf bank_mask:0x3
    v_mov_b32_dpp v78, v74 row_ror:8 row_mask:0xf bank_mask:0x3
    v_mov_b32_dpp v79, v75 row_ror:8 row_mask:0xf bank_mask:0x3
    v_permlane16_swap_b32 v80, v82
    v_permlane16_swap_b32 v81, v83
    v_permlane16_swap_b32 v68, v70
    v_permlane16_swap_b32 v69, v71
    s_cmp_ge_u32 s80, 3
    s_cbranch_scc1 L_tg40
L_tb40:
    s_barrier
    s_cmp_eq_u32 s38, 1
    s_cbranch_scc1 L_c41
    v_mov_b32 v254, 1
    s_mov_b64 exec, s[78:79]
    buffer_atomic_add v254, off, s[72:75], s76 sc0 sc1
    s_mov_b64 exec, -1
L_c41:
    v_permlane16_swap_b32 v64, v66
    v_permlane16_swap_b32 v65, v67
    v_permlane16_swap_b32 v76, v78
    v_permlane16_swap_b32 v77, v79
    v_mul_f32 v96, v96, v236
    v_mul_f32 v97, v97, v236
    v_mul_f32 v98, v98, v236
    v_mul_f32 v99, v99, v236
    v_mul_f32 v100, v100, v236
    v_mul_f32 v101, v101, v236
    v_mul_f32 v102, v102, v236
    v_mul_f32 v103, v103, v236
    v_cvt_pk_bf16_f32 v96, v96, v97
    v_cvt_pk_bf16_f32 v97, v98, v99
    v_cvt_pk_bf16_f32 v98, v100, v101
    v_cvt_pk_bf16_f32 v99, v102, v103
    v_mul_f32 v104, v104, v236
    s_waitcnt vmcnt(5)
    buffer_store_dwordx4 v[80:83], v253, s[24:27], s43 offen sc1
    v_mul_f32 v105, v105, v236
    v_mul_f32 v106, v106, v236
    v_mul_f32 v107, v107, v236
    v_mul_f32 v108, v108, v236
    v_mul_f32 v109, v109, v236
    v_mul_f32 v110, v110, v236
    v_mul_f32 v111, v111, v236
    v_cvt_pk_bf16_f32 v100, v104, v105
    v_cvt_pk_bf16_f32 v101, v106, v107
    v_cvt_pk_bf16_f32 v102, v108, v109
    v_cvt_pk_bf16_f32 v103, v110, v111
    v_mul_f32 v112, v112, v240
    v_mul_f32 v113, v113, v240
    v_mul_f32 v114, v114, v240
    v_mul_f32 v115, v115, v240
    v_mul_f32 v116, v116, v240
    v_mul_f32 v117, v117, v240
    s_waitcnt vmcnt(5)
    buffer_store_dwordx4 v[68:71], v253, s[24:27], s43 offen offset:3072 sc1
    v_mul_f32 v118, v118, v240
    v_mul_f32 v119, v119, v240
    v_cvt_pk_bf16_f32 v104, v112, v113
    v_cvt_pk_bf16_f32 v105, v114, v115
    v_cvt_pk_bf16_f32 v106, v116, v117
    v_cvt_pk_bf16_f32 v107, v118, v119
    v_mul_f32 v120, v120, v240
    v_mul_f32 v121, v121, v240
    v_mul_f32 v122, v122, v240
    v_mul_f32 v123, v123, v240
    v_mul_f32 v124, v124, v240
    v_mul_f32 v125, v125, v240
    v_mul_f32 v126, v126, v240
    v_mul_f32 v127, v127, v240
    v_cvt_pk_bf16_f32 v108, v120, v121
    v_cvt_pk_bf16_f32 v109, v122, v123
    v_cvt_pk_bf16_f32 v110, v124, v125
    s_waitcnt vmcnt(5)
    buffer_store_dwordx4 v[64:67], v253, s[24:27], s44 offen sc1
    v_cvt_pk_bf16_f32 v111, v126, v127
    v_cndmask_b32_dpp v112, v100, v96, vcc row_ror:8 row_mask:0xf bank_mask:0xf
    v_cndmask_b32_dpp v113, v101, v97, vcc row_ror:8 row_mask:0xf bank_mask:0xf
    v_cndmask_b32_dpp v114, v102, v98, vcc row_ror:8 row_mask:0xf bank_mask:0xf
    v_cndmask_b32_dpp v115, v103, v99, vcc row_ror:8 row_mask:0xf bank_mask:0xf
    v_mov_b32_dpp v100, v96 row_ror:8 row_mask:0xf bank_mask:0x3
    v_mov_b32_dpp v101, v97 row_ror:8 row_mask:0xf bank_mask:0x3
    v_mov_b32_dpp v102, v98 row_ror:8 row_mask:0xf bank_mask:0x3
    v_mov_b32_dpp v103, v99 row_ror:8 row_mask:0xf bank_mask:0x3
    v_cndmask_b32_dpp v96, v108, v104, vcc row_ror:8 row_mask:0xf bank_mask:0xf
    v_cndmask_b32_dpp v97, v109, v105, vcc row_ror:8 row_mask:0xf bank_mask:0xf
    v_cndmask_b32_dpp v98, v110, v106, vcc row_ror:8 row_mask:0xf bank_mask:0xf
    v_cndmask_b32_dpp v99, v111, v107, vcc row_ror:8 row_mask:0xf bank_mask:0xf
    v_mov_b32_dpp v108, v104 row_ror:8 row_mask:0xf bank_mask:0x3
    v_mov_b32_dpp v109, v105 row_ror:8 row_mask:0xf bank_mask:0x3
    v_mov_b32_dpp v110, v106 row_ror:8 row_mask:0xf bank_mask:0x3
    v_mov_b32_dpp v111, v107 row_ror:8 row_mask:0xf bank_mask:0x3
    s_cmp_ge_u32 s80, 2
    s_cbranch_scc1 L_tg42
L_tb42:
    s_barrier
    s_waitcnt vmcnt(5)
    buffer_store_dwordx4 v[76:79], v253, s[24:27], s44 offen offset:3072 sc1
    v_permlane16_swap_b32 v112, v114
    v_permlane16_swap_b32 v113, v115
    v_permlane16_swap_b32 v100, v102
    v_permlane16_swap_b32 v101, v103
    v_permlane16_swap_b32 v96, v98
    v_permlane16_swap_b32 v97, v99
    v_permlane16_swap_b32 v108, v110
    v_permlane16_swap_b32 v109, v111
    v_mul_f32 v180, v180, v236
    v_mul_f32 v181, v181, v236
    v_mul_f32 v182, v182, v236
    v_mul_f32 v183, v183, v236
    s_cmp_eq_u32 s38, 1
    s_cbranch_scc1 L_c43
    s_waitcnt vmcnt(4)
L_c43:
    v_subrev_u32 v254, s77, v254
    s_mov_b64 exec, s[78:79]
    ds_write_b32 v247, v254
    s_mov_b64 exec, -1
    s_add_u32 s77, s77, 16
    v_mul_f32 v184, v184, v236
    v_mul_f32 v185, v185, v236
    v_mul_f32 v186, v186, v236
    v_mul_f32 v187, v187, v236
    v_cvt_pk_bf16_f32 v180, v180, v181
    v_cvt_pk_bf16_f32 v181, v182, v183
    v_cvt_pk_bf16_f32 v182, v184, v185
    v_cvt_pk_bf16_f32 v183, v186, v187
    v_mul_f32 v188, v188, v236
    v_mul_f32 v189, v189, v236
    v_mul_f32 v190, v190, v236
    v_mul_f32 v191, v191, v236
    v_mul_f32 v192, v192, v236
    s_waitcnt vmcnt(5)
    buffer_store_dwordx4 v[112:115], v253, s[24:27], s43 offen offset:128 sc1
    v_mul_f32 v193, v193, v236
    v_mul_f32 v194, v194, v236
    v_mul_f32 v195, v195, v236
    v_cvt_pk_bf16_f32 v184, v188, v189
    v_cvt_pk_bf16_f32 v185, v190, v191
    v_cvt_pk_bf16_f32 v186, v192, v193
    v_cvt_pk_bf16_f32 v187, v194, v195
    v_mul_f32 v196, v196, v240
    v_mul_f32 v197, v197, v240
    v_mul_f32 v198, v198, v240
    v_mul_f32 v199, v199, v240
    v_mul_f32 v200, v200, v240
    v_mul_f32 v201, v201, v240
    s_waitcnt lgkmcnt(0)
    v_mul_f32 v202, v202, v240
    v_mul_f32 v203, v203, v240
    v_cvt_pk_bf16_f32 v188, v196, v197
    v_cvt_pk_bf16_f32 v189, v198, v199
    v_cvt_pk_bf16_f32 v190, v200, v201
    v_cvt_pk_bf16_f32 v191, v202, v203
    v_mul_f32 v204, v204, v240
    v_mul_f32 v205, v205, v240
    v_mul_f32 v206, v206, v240
    v_mul_f32 v207, v207, v240
    v_mul_f32 v208, v208, v240
    v_mul_f32 v209, v209, v240
    v_mul_f32 v210, v210, v240
    s_waitcnt vmcnt(5)
    buffer_store_dwordx4 v[100:103], v253, s[24:27], s43 offen offset:3200 sc1
    v_mul_f32 v211, v211, v240
    v_cvt_pk_bf16_f32 v192, v204, v205
    v_cvt_pk_bf16_f32 v193, v206, v207
    v_cvt_pk_bf16_f32 v194, v208, v209
    v_cvt_pk_bf16_f32 v195, v210, v211
    v_cndmask_b32_dpp v196, v184, v180, vcc row_ror:8 row_mask:0xf bank_mask:0xf
    v_cndmask_b32_dpp v197, v185, v181, vcc row_ror:8 row_mask:0xf bank_mask:0xf
    v_cndmask_b32_dpp v198, v186, v182, vcc row_ror:8 row_mask:0xf bank_mask:0xf
    v_cndmask_b32_dpp v199, v187, v183, vcc row_ror:8 row_mask:0xf bank_mask:0xf
    v_mov_b32_dpp v184, v180 row_ror:8 row_mask:0xf bank_mask:0x3
    v_mov_b32_dpp v185, v181 row_ror:8 row_mask:0xf bank_mask:0x3
    v_mov_b32_dpp v186, v182 row_ror:8 row_mask:0xf bank_mask:0x3
    v_mov_b32_dpp v187, v183 row_ror:8 row_mask:0xf bank_mask:0x3
    s_cmp_ge_u32 s80, 3
    s_cbranch_scc1 L_tg44
L_tb44:
    s_barrier
    ds_read_b32 v254, v247
    v_cndmask_b32_dpp v180, v192, v188, vcc row_ror:8 row_mask:0xf bank_mask:0xf
    v_cndmask_b32_dpp v181, v193, v189, vcc row_ror:8 row_mask:0xf bank_mask:0xf
    v_cndmask_b32_dpp v182, v194, v190, vcc row_ror:8 row_mask:0xf bank_mask:0xf
    v_cndmask_b32_dpp v183, v195, v191, vcc row_ror:8 row_mask:0xf bank_mask:0xf
    v_mov_b32_dpp v192, v188 row_ror:8 row_mask:0xf bank_mask:0x3
    v_mov_b32_dpp v193, v189 row_ror:8 row_mask:0xf bank_mask:0x3
    v_mov_b32_dpp v194, v190 row_ror:8 row_mask:0xf bank_mask:0x3
    v_mov_b32_dpp v195, v191 row_ror:8 row_mask:0xf bank_mask:0x3
    v_permlane16_swap_b32 v196, v198
    v_permlane16_swap_b32 v197, v199
    v_permlane16_swap_b32 v184, v186
    v_permlane16_swap_b32 v185, v187
    v_permlane16_swap_b32 v180, v182
    s_waitcnt vmcnt(5)
    buffer_store_dwordx4 v[96:99], v253, s[24:27], s44 offen offset:128 sc1
    v_permlane16_swap_b32 v181, v183
    v_permlane16_swap_b32 v192, v194
    v_permlane16_swap_b32 v193, v195
    v_cndmask_b32_dpp v128, v136, v132, vcc row_ror:8 row_mask:0xf bank_mask:0xf
    v_cndmask_b32_dpp v129, v137, v133, vcc row_ror:8 row_mask:0xf bank_mask:0xf
    v_cndmask_b32_dpp v130, v138, v134, vcc row_ror:8 row_mask:0xf bank_mask:0xf
    v_cndmask_b32_dpp v131, v139, v135, vcc row_ror:8 row_mask:0xf bank_mask:0xf
    v_mov_b32_dpp v136, v132 row_ror:8 row_mask:0xf bank_mask:0x3
    v_mov_b32_dpp v137, v133 row_ror:8 row_mask:0xf bank_mask:0x3
    v_mov_b32_dpp v138, v134 row_ror:8 row_mask:0xf bank_mask:0x3
    v_mov_b32_dpp v139, v135 row_ror:8 row_mask:0xf bank_mask:0x3
    v_cndmask_b32_dpp v132, v144, v140, vcc row_ror:8 row_mask:0xf bank_mask:0xf
    s_waitcnt lgkmcnt(0)
    v_readfirstlane_b32 s81, v254
    s_cmp_lt_i32 s81, 10
    s_cselect_b32 s80, 1, 0
    s_cmp_lt_i32 s81, 6
    s_cselect_b32 s80, 2, s80
    s_cmp_lt_i32 s81, 3
    s_cselect_b32 s80, 3, s80
    s_cmp_eq_u32 s38, 1
    s_cselect_b32 s80, 0, s80
    s_cmp_le_u32 s38, 2
    s_cselect_b32 s81, 2, 9
    s_min_u32 s80, s80, s81
    s_cmp_le_u32 s38, 1
    s_cselect_b32 s81, 1, 9
    s_min_u32 s80, s80, s81
    v_cndmask_b32_dpp v133, v145, v141, vcc row_ror:8 row_mask:0xf bank_mask:0xf
    v_cndmask_b32_dpp v134, v146, v142, vcc row_ror:8 row_mask:0xf bank_mask:0xf
    v_cndmask_b32_dpp v135, v147, v143, vcc row_ror:8 row_mask:0xf bank_mask:0xf
    v_mov_b32_dpp v144, v140 row_ror:8 row_mask:0xf bank_mask:0x3
    v_mov_b32_dpp v145, v141 row_ror:8 row_mask:0xf bank_mask:0x3
    v_mov_b32_dpp v146, v142 row_ror:8 row_mask:0xf bank_mask:0x3
    v_mov_b32_dpp v147, v143 row_ror:8 row_mask:0xf bank_mask:0x3
    v_cndmask_b32_dpp v140, v152, v148, vcc row_ror:8 row_mask:0xf bank_mask:0xf
    v_cndmask_b32_dpp v141, v153, v149, vcc row_ror:8 row_mask:0xf bank_mask:0xf
    v_cndmask_b32_dpp v142, v154, v150, vcc row_ror:8 row_mask:0xf bank_mask:0xf
    v_cndmask_b32_dpp v143, v155, v151, vcc row_ror:8 row_mask:0xf bank_mask:0xf
    v_mov_b32_dpp v152, v148 row_ror:8 row_mask:0xf bank_mask:0x3
    v_mov_b32_dpp v153, v149 row_ror:8 row_mask:0xf bank_mask:0x3
    s_waitcnt vmcnt(5)
    buffer_store_dwordx4 v[108:111], v253, s[24:27], s44 offen offset:3200 sc1
    v_mov_b32_dpp v154, v150 row_ror:8 row_mask:0xf bank_mask:0x3
    v_mov_b32_dpp v155, v151 row_ror:8 row_mask:0xf bank_mask:0x3
    v_cndmask_b32_dpp v148, v160, v156, vcc row_ror:8 row_mask:0xf bank_mask:0xf
    v_cndmask_b32_dpp v149, v161, v157, vcc row_ror:8 row_mask:0xf bank_mask:0xf
    v_cndmask_b32_dpp v150, v162, v158, vcc row_ror:8 row_mask:0xf bank_mask:0xf
    v_cndmask_b32_dpp v151, v163, v159, vcc row_ror:8 row_mask:0xf bank_mask:0xf
    v_mov_b32_dpp v160, v156 row_ror:8 row_mask:0xf bank_mask:0x3
    v_mov_b32_dpp v161, v157 row_ror:8 row_mask:0xf bank_mask:0x3
    v_mov_b32_dpp v162, v158 row_ror:8 row_mask:0xf bank_mask:0x3
    v_mov_b32_dpp v163, v159 row_ror:8 row_mask:0xf bank_mask:0x3
    v_cndmask_b32_dpp v156, v168, v164, vcc row_ror:8 row_mask:0xf bank_mask:0xf
    v_cndmask_b32_dpp v157, v169, v165, vcc row_ror:8 row_mask:0xf bank_mask:0xf
    s_cmp_eq_u32 s38, 2
    s_cbranch_scc1 L_c45
    s_waitcnt vmcnt(5)
    buffer_store_dwordx4 v[196:199], v253, s[24:27], s43 offen offset:256 sc1
L_c45:
    v_cndmask_b32_dpp v158, v170, v166, vcc row_ror:8 row_mask:0xf bank_mask:0xf
    v_cndmask_b32_dpp v159, v171, v167, vcc row_ror:8 row_mask:0xf bank_mask:0xf
    v_mov_b32_dpp v168, v164 row_ror:8 row_mask:0xf bank_mask:0x3
    v_mov_b32_dpp v169, v165 row_ror:8 row_mask:0xf bank_mask:0x3
    v_mov_b32_dpp v170, v166 row_ror:8 row_mask:0xf bank_mask:0x3
    v_mov_b32_dpp v171, v167 row_ror:8 row_mask:0xf bank_mask:0x3
    v_cndmask_b32_dpp v164, v176, v172, vcc row_ror:8 row_mask:0xf bank_mask:0xf
    v_cndmask_b32_dpp v165, v177, v173, vcc row_ror:8 row_mask:0xf bank_mask:0xf
    v_cndmask_b32_dpp v166, v178, v174, vcc row_ror:8 row_mask:0xf bank_mask:0xf
    v_cndmask_b32_dpp v167, v179, v175, vcc row_ror:8 row_mask:0xf bank_mask:0xf
    v_add_u32 v249, s37, v247
    v_xor_b32 v251, 64, v249
    s_nop 0
    ds_read_b128 v[212:215], v249 offset:0
    ds_read_b128 v[216:219], v249 offset:6144
    ds_read_b128 v[220:223], v249 offset:12288
    ds_read_b128 v[224:227], v249 offset:18432
    ds_read_b128 v[228:231], v251 offset:0
    s_add_u32 s37, s37, 24576
    s_cmp_eq_u32 s37, 147584
    s_cselect_b32 s37, 128, s37
    s_cselect_b32 s28, s29, 24576
    v_mov_b32_dpp v176, v172 row_ror:8 row_mask:0xf bank_mask:0x3
    v_mov_b32_dpp v177, v173 row_ror:8 row_mask:0xf bank_mask:0x3
    v_mov_b32_dpp v178, v174 row_ror:8 row_mask:0xf bank_mask:0x3
    v_mov_b32_dpp v179, v175 row_ror:8 row_mask:0xf bank_mask:0x3
    s_cmp_ge_u32 s80, 1
    s_cbranch_scc1 L_tg46
L_tb46:
    s_barrier
    s_mov_b32 s34, s35
    s_add_u32 s35, s35, 25165824
    s_add_u32 s42, s35, 6144
    s_sub_u32 s38, s38, 1
    s_cmp_lg_u32 s38, 0
    s_cbranch_scc1 L_headA
    buffer_store_dwordx4 v[184:187], v253, s[24:27], s43 offen offset:3328 sc1
    buffer_store_dwordx4 v[180:183], v253, s[24:27], s44 offen offset:256 sc1
    buffer_store_dwordx4 v[192:195], v253, s[24:27], s44 offen offset:3328 sc1
    s_endpgm
L_grpB:
    s_mov_b32 m0, s36
    s_nop 0
    buffer_load_dwordx4 v244, s[16:19], s34 offen nt lds
    buffer_load_dwordx4 v245, s[16:19], s34 offen offset:1024 nt lds
    buffer_load_dwordx4 v246, s[16:19], s34 offen offset:2048 nt lds
    s_add_u32 s36, s36, 24576
    s_cmp_eq_u32 s36, s45
    s_cselect_b32 s36, s33, s36
    s_and_b32 s73, s73, 0xffff
    s_mov_b32 s74, 402653184
    s_mov_b32 s75, 0x20000
    s_lshr_b32 s76, s2, 4
    s_mul_i32 s76, s76, 4352
    s_add_u32 s76, s76, 0x200000
    s_cmp_eq_u32 s32, 0
    s_cselect_b32 s78, 1, 0
    s_mov_b32 s79, 0
    s_mov_b32 s80, 0
    s_mov_b32 s82, 0
    v_and_b32 v7, 15, v1
    v_bfe_u32 v9, v7, 3, 1
    v_and_or_b32 v9, v7, 6, v9
    v_bfe_u32 v10, v1, 4, 1
    v_lshl_or_b32 v10, v10, 1, v8
    v_xor_b32 v9, v9, v10
    v_mul_u32_u24 v10, 384, v7
    v_lshl_add_u32 v247, v9, 4, v10
    v_lshrrev_b32 v7, 2, v1
    v_and_or_b32 v9, v7, 6, v8
    v_bfe_u32 v10, v1, 1, 1
    v_xor_b32 v9, v9, v10
    v_mul_u32_u24 v10, 384, v7
    v_lshl_add_u32 v10, v9, 4, v10
    v_and_b32 v11, 1, v1
    v_lshl_add_u32 v248, v11, 3, v10
    v_mov_b32 v232, 0x3f803f80
    v_mov_b32 v233, 0x3f803f80
    v_mov_b32 v234, 0x3f803f80
    v_mov_b32 v235, 0x3f803f80
    s_mov_b32 s37, 128
    s_mov_b32 s29, -122880
    s_mov_b32 s38, 4
    s_mov_b32 s39, 0x3dd53b95
    s_mov_b32 s40, 0xbdd53b95
    s_add_u32 s35, s34, 25165824
    s_add_u32 s42, s35, 6144
    s_mov_b32 s43, s34
    s_mov_b32 s44, s34
    s_mov_b32 vcc_lo, 0x00ff00ff
    s_mov_b32 vcc_hi, 0x00ff00ff
    s_add_u32 s44, s34, 6144
    s_waitcnt vmcnt(0)
    s_barrier
    s_sub_u32 m0, s36, 12288
    s_add_u32 s41, s34, 12288
    buffer_load_dwordx4 v244, s[16:19], s41 offen nt lds
    buffer_load_dwordx4 v245, s[16:19], s41 offen offset:1024 nt lds
    buffer_load_dwordx4 v246, s[16:19], s41 offen offset:2048 nt lds
    s_mov_b32 m0, s36
    s_add_u32 s41, s34, 24576
    buffer_load_dwordx4 v244, s[16:19], s41 offen nt lds
    buffer_load_dwordx4 v245, s[16:19], s41 offen offset:1024 nt lds
    buffer_load_dwordx4 v246, s[16:19], s41 offen offset:2048 nt lds
    s_add_u32 s36, s36, 24576
    s_cmp_eq_u32 s36, s45
    s_cselect_b32 s36, s33, s36
    s_sub_u32 m0, s36, 12288
    s_add_u32 s41, s34, 36864
    buffer_load_dwordx4 v244, s[16:19], s41 offen nt lds
    buffer_load_dwordx4 v245, s[16:19], s41 offen offset:1024 nt lds
    buffer_load_dwordx4 v246, s[16:19], s41 offen offset:2048 nt lds
    s_mov_b32 m0, s36
    s_add_u32 s41, s34, 49152
    buffer_load_dwordx4 v244, s[16:19], s41 offen nt lds
    buffer_load_dwordx4 v245, s[16:19], s41 offen offset:1024 nt lds
    buffer_load_dwordx4 v246, s[16:19], s41 offen offset:2048 nt lds
    s_add_u32 s36, s36, 24576
    s_cmp_eq_u32 s36, s45
    s_cselect_b32 s36, s33, s36
    buffer_load_dwordx4 v[132:135], v253, s[12:15], s34 offen nt
    buffer_load_dwordx4 v[136:139], v253, s[12:15], s34 offen offset:3072 nt
    buffer_load_dwordx4 v[140:143], v253, s[12:15], s44 offen nt
    buffer_load_dwordx4 v[144:147], v253, s[12:15], s44 offen offset:3072 nt
    s_waitcnt vmcnt(10)
    s_waitcnt lgkmcnt(0)
    s_barrier
    s_sub_u32 m0, s36, 12288
    s_add_u32 s41, s34, 61440
    buffer_load_dwordx4 v244, s[16:19], s41 offen nt lds
    buffer_load_dwordx4 v245, s[16:19], s41 offen offset:1024 nt lds
    buffer_load_dwordx4 v246, s[16:19], s41 offen offset:2048 nt lds
    s_mov_b32 m0, s36
    s_add_u32 s41, s34, 73728
    buffer_load_dwordx4 v244, s[16:19], s41 offen nt lds
    buffer_load_dwordx4 v245, s[16:19], s41 offen offset:1024 nt lds
    buffer_load_dwordx4 v246, s[16:19], s41 offen offset:2048 nt lds
    s_add_u32 s36, s36, 24576
    s_cmp_eq_u32 s36, s45
    s_cselect_b32 s36, s33, s36
    s_add_u32 s36, s33, 0
    buffer_load_dwordx4 v[148:151], v253, s[12:15], s34 offen offset:128 nt
    buffer_load_dwordx4 v[152:155], v253, s[12:15], s34 offen offset:3200 nt
    buffer_load_dwordx4 v[156:159], v253, s[12:15], s44 offen offset:128 nt
    buffer_load_dwordx4 v[160:163], v253, s[12:15], s44 offen offset:3200 nt
    buffer_load_dwordx4 v[164:167], v253, s[12:15], s34 offen offset:256 nt
    buffer_load_dwordx4 v[168:171], v253, s[12:15], s34 offen offset:3328 nt
    buffer_load_dwordx4 v[172:175], v253, s[12:15], s44 offen offset:256 nt
    buffer_load_dwordx4 v[176:179], v253, s[12:15], s44 offen offset:3328 nt
    s_waitcnt vmcnt(18)
    s_waitcnt lgkmcnt(0)
    s_barrier
    s_waitcnt vmcnt(8)
    s_waitcnt lgkmcnt(0)
    s_barrier
    s_waitcnt vmcnt(14)
    v_cndmask_b32_dpp v128, v136, v132, vcc row_ror:8 row_mask:0xf bank_mask:0xf
    v_cndmask_b32_dpp v129, v137, v133, vcc row_ror:8 row_mask:0xf bank_mask:0xf
    v_cndmask_b32_dpp v130, v138, v134, vcc row_ror:8 row_mask:0xf bank_mask:0xf
    v_cndmask_b32_dpp v131, v139, v135, vcc row_ror:8 row_mask:0xf bank_mask:0xf
    v_mov_b32_dpp v136, v132 row_ror:8 row_mask:0xf bank_mask:0x3
    v_mov_b32_dpp v137, v133 row_ror:8 row_mask:0xf bank_mask:0x3
    v_mov_b32_dpp v138, v134 row_ror:8 row_mask:0xf bank_mask:0x3
    v_mov_b32_dpp v139, v135 row_ror:8 row_mask:0xf bank_mask:0x3
    v_cndmask_b32_dpp v132, v144, v140, vcc row_ror:8 row_mask:0xf bank_mask:0xf
    v_cndmask_b32_dpp v133, v145, v141, vcc row_ror:8 row_mask:0xf bank_mask:0xf
    v_cndmask_b32_dpp v134, v146, v142, vcc row_ror:8 row_mask:0xf bank_mask:0xf
    v_cndmask_b32_dpp v135, v147, v143, vcc row_ror:8 row_mask:0xf bank_mask:0xf
    v_mov_b32_dpp v144, v140 row_ror:8 row_mask:0xf bank_mask:0x3
    v_mov_b32_dpp v145, v141 row_ror:8 row_mask:0xf bank_mask:0x3
    v_mov_b32_dpp v146, v142 row_ror:8 row_mask:0xf bank_mask:0x3
    v_mov_b32_dpp v147, v143 row_ror:8 row_mask:0xf bank_mask:0x3
    s_waitcnt vmcnt(4)
    v_cndmask_b32_dpp v140, v152, v148, vcc row_ror:8 row_mask:0xf bank_mask:0xf
    v_cndmask_b32_dpp v141, v153, v149, vcc row_ror:8 row_mask:0xf bank_mask:0xf
    v_cndmask_b32_dpp v142, v154, v150, vcc row_ror:8 row_mask:0xf bank_mask:0xf
    v_cndmask_b32_dpp v143, v155, v151, vcc row_ror:8 row_mask:0xf bank_mask:0xf
    v_mov_b32_dpp v152, v148 row_ror:8 row_mask:0xf bank_mask:0x3
    v_mov_b32_dpp v153, v149 row_ror:8 row_mask:0xf bank_mask:0x3
    v_mov_b32_dpp v154, v150 row_ror:8 row_mask:0xf bank_mask:0x3
    v_mov_b32_dpp v155, v151 row_ror:8 row_mask:0xf bank_mask:0x3
    v_cndmask_b32_dpp v148, v160, v156, vcc row_ror:8 row_mask:0xf bank_mask:0xf
    v_cndmask_b32_dpp v149, v161, v157, vcc row_ror:8 row_mask:0xf bank_mask:0xf
    v_cndmask_b32_dpp v150, v162, v158, vcc row_ror:8 row_mask:0xf bank_mask:0xf
    v_cndmask_b32_dpp v151, v163, v159, vcc row_ror:8 row_mask:0xf bank_mask:0xf
    v_mov_b32_dpp v160, v156 row_ror:8 row_mask:0xf bank_mask:0x3
    v_mov_b32_dpp v161, v157 row_ror:8 row_mask:0xf bank_mask:0x3
    v_mov_b32_dpp v162, v158 row_ror:8 row_mask:0xf bank_mask:0x3
    v_mov_b32_dpp v163, v159 row_ror:8 row_mask:0xf bank_mask:0x3
    s_waitcnt vmcnt(0)
    v_cndmask_b32_dpp v156, v168, v164, vcc row_ror:8 row_mask:0xf bank_mask:0xf
    v_cndmask_b32_dpp v157, v169, v165, vcc row_ror:8 row_mask:0xf bank_mask:0xf
    v_cndmask_b32_dpp v158, v170, v166, vcc row_ror:8 row_mask:0xf bank_mask:0xf
    v_cndmask_b32_dpp v159, v171, v167, vcc row_ror:8 row_mask:0xf bank_mask:0xf
    v_mov_b32_dpp v168, v164 row_ror:8 row_mask:0xf bank_mask:0x3
    v_mov_b32_dpp v169, v165 row_ror:8 row_mask:0xf bank_mask:0x3
    v_mov_b32_dpp v170, v166 row_ror:8 row_mask:0xf bank_mask:0x3
    v_mov_b32_dpp v171, v167 row_ror:8 row_mask:0xf bank_mask:0x3
    v_cndmask_b32_dpp v164, v176, v172, vcc row_ror:8 row_mask:0xf bank_mask:0xf
    v_cndmask_b32_dpp v165, v177, v173, vcc row_ror:8 row_mask:0xf bank_mask:0xf
    v_cndmask_b32_dpp v166, v178, v174, vcc row_ror:8 row_mask:0xf bank_mask:0xf
    v_cndmask_b32_dpp v167, v179, v175, vcc row_ror:8 row_mask:0xf bank_mask:0xf
    v_mov_b32_dpp v176, v172 row_ror:8 row_mask:0xf bank_mask:0x3
    v_mov_b32_dpp v177, v173 row_ror:8 row_mask:0xf bank_mask:0x3
    v_mov_b32_dpp v178, v174 row_ror:8 row_mask:0xf bank_mask:0x3
    v_mov_b32_dpp v179, v175 row_ror:8 row_mask:0xf bank_mask:0x3
    s_waitcnt lgkmcnt(0)
    s_barrier
    v_add_u32 v249, s37, v247
    v_xor_b32 v251, 64, v249
    s_nop 0
    ds_read_b128 v[212:215], v249 offset:0
    ds_read_b128 v[216:219], v249 offset:6144
    ds_read_b128 v[220:223], v249 offset:12288
    ds_read_b128 v[224:227], v249 offset:18432
    ds_read_b128 v[228:231], v251 offset:0
    s_add_u32 s37, s37, 24576
    s_cmp_eq_u32 s37, 147584
    s_cselect_b32 s37, 128, s37
    s_cselect_b32 s28, s29, 24576
.p2align 6
L_headB:
    s_waitcnt lgkmcnt(3)
    v_mfma_f32_16x16x32_bf16 v[0:3], v[212:215], v[128:131], 0
    s_cmp_eq_u32 s38, 1
    s_cbranch_scc1 L_c47
    s_waitcnt vmcnt(5)
    buffer_store_dwordx4 v[184:187], v253, s[24:27], s43 offen offset:3328 sc1
L_c47:
    v_mfma_f32_16x16x32_bf16 v[8:11], v[212:215], v[132:135], 0
    ds_read_b128 v[212:215], v251 offset:6144
    v_mfma_f32_16x16x32_bf16 v[4:7], v[216:219], v[128:131], 0
    v_mfma_f32_16x16x32_bf16 v[12:15], v[216:219], v[132:135], 0
    ds_read_b128 v[216:219], v251 offset:12288
    s_waitcnt lgkmcnt(3)
    v_mfma_f32_16x16x32_bf16 v[16:19], v[220:223], v[128:131], 0
    v_mfma_f32_16x16x32_bf16 v[24:27], v[220:223], v[132:135], 0
    ds_read_b128 v[220:223], v251 offset:18432
    v_mfma_f32_16x16x32_bf16 v[20:23], v[224:227], v[128:131], 0
    v_mfma_f32_16x16x32_bf16 v[28:31], v[224:227], v[132:135], 0
    ds_read_b128 v[224:227], v249 offset:128
    s_waitcnt lgkmcnt(3)
    v_mfma_f32_16x16x32_bf16 v[0:3], v[228:231], v[136:139], v[0:3]
    s_cmp_eq_u32 s38, 1
    s_cbranch_scc1 L_c48
    s_waitcnt vmcnt(5)
    buffer_store_dwordx4 v[180:183], v253, s[24:27], s44 offen offset:256 sc1
L_c48:
    v_mfma_f32_16x16x32_bf16 v[8:11], v[228:231], v[144:147], v[8:11]
    ds_read_b128 v[228:231], v249 offset:6272
    v_mfma_f32_16x16x32_bf16 v[4:7], v[212:215], v[136:139], v[4:7]
    v_mfma_f32_16x16x32_bf16 v[12:15], v[212:215], v[144:147], v[12:15]
    ds_read_b128 v[212:215], v249 offset:12416
    s_waitcnt lgkmcnt(3)
    v_mfma_f32_16x16x32_bf16 v[16:19], v[216:219], v[136:139], v[16:19]
    v_mfma_f32_16x16x32_bf16 v[24:27], v[216:219], v[144:147], v[24:27]
    ds_read_b128 v[216:219], v249 offset:18560
    v_mfma_f32_16x16x32_bf16 v[20:23], v[220:223], v[136:139], v[20:23]
    v_mfma_f32_16x16x32_bf16 v[28:31], v[220:223], v[144:147], v[28:31]
    ds_read_b128 v[220:223], v251 offset:128
    s_waitcnt lgkmcnt(3)
    v_mfma_f32_16x16x32_bf16 v[0:3], v[224:227], v[140:143], v[0:3]
    s_cmp_eq_u32 s38, 1
    s_cbranch_scc1 L_c49
    s_waitcnt vmcnt(5)
    buffer_store_dwordx4 v[192:195], v253, s[24:27], s44 offen offset:3328 sc1
L_c49:
    v_mfma_f32_16x16x32_bf16 v[8:11], v[224:227], v[148:151], v[8:11]
    ds_read_b128 v[224:227], v251 offset:6272
    v_mfma_f32_16x16x32_bf16 v[4:7], v[228:231], v[140:143], v[4:7]
    v_mfma_f32_16x16x32_bf16 v[12:15], v[228:231], v[148:151], v[12:15]
    ds_read_b128 v[228:231], v251 offset:12416
    s_waitcnt lgkmcnt(3)
    v_mfma_f32_16x16x32_bf16 v[16:19], v[212:215], v[140:143], v[16:19]
    v_mfma_f32_16x16x32_bf16 v[24:27], v[212:215], v[148:151], v[24:27]
    ds_read_b128 v[212:215], v251 offset:18560
    v_mfma_f32_16x16x32_bf16 v[20:23], v[216:219], v[140:143], v[20:23]
    v_mfma_f32_16x16x32_bf16 v[28:31], v[216:219], v[148:151], v[28:31]
    ds_read_b128 v[216:219], v249 offset:256
    s_waitcnt lgkmcnt(3)
    v_mfma_f32_16x16x32_bf16 v[0:3], v[220:223], v[152:155], v[0:3]
    s_cmp_eq_u32 s38, 1
    s_cbranch_scc0 L_c50
    s_waitcnt vmcnt(5)
    buffer_store_dwordx4 v[112:115], v253, s[24:27], s43 offen offset:128 sc1
L_c50:
    v_mfma_f32_16x16x32_bf16 v[8:11], v[220:223], v[160:163], v[8:11]
    ds_read_b128 v[220:223], v249 offset:6400
    v_mfma_f32_16x16x32_bf16 v[4:7], v[224:227], v[152:155], v[4:7]
    v_mfma_f32_16x16x32_bf16 v[12:15], v[224:227], v[160:163], v[12:15]
    ds_read_b128 v[224:227], v249 offset:12544
    s_waitcnt lgkmcnt(3)
    v_mfma_f32_16x16x32_bf16 v[16:19], v[228:231], v[152:155], v[16:19]
    v_mfma_f32_16x16x32_bf16 v[24:27], v[228:231], v[160:163], v[24:27]
    ds_read_b128 v[228:231], v249 offset:18688
    v_mfma_f32_16x16x32_bf16 v[20:23], v[212:215], v[152:155], v[20:23]
    v_mfma_f32_16x16x32_bf16 v[28:31], v[212:215], v[160:163], v[28:31]
    ds_read_b128 v[212:215], v251 offset:256
    s_waitcnt lgkmcnt(3)
    v_mfma_f32_16x16x32_bf16 v[0:3], v[216:219], v[156:159], v[0:3]
    v_add_u32 v249, s28, v249
    s_cmp_eq_u32 s38, 1
    s_cbranch_scc0 L_c51
    s_waitcnt vmcnt(5)
    buffer_store_dwordx4 v[100:103], v253, s[24:27], s43 offen offset:3200 sc1
L_c51:
    v_mfma_f32_16x16x32_bf16 v[8:11], v[216:219], v[164:167], v[8:11]
    ds_read_b128 v[216:219], v251 offset:6400
    v_mfma_f32_16x16x32_bf16 v[4:7], v[220:223], v[156:159], v[4:7]
    v_mfma_f32_16x16x32_bf16 v[12:15], v[220:223], v[164:167], v[12:15]
    ds_read_b128 v[220:223], v251 offset:12544
    s_waitcnt lgkmcnt(3)
    v_mfma_f32_16x16x32_bf16 v[16:19], v[224:227], v[156:159], v[16:19]
    v_mfma_f32_16x16x32_bf16 v[24:27], v[224:227], v[164:167], v[24:27]
    ds_read_b128 v[224:227], v251 offset:18688
    v_mfma_f32_16x16x32_bf16 v[20:23], v[228:231], v[156:159], v[20:23]
    v_mfma_f32_16x16x32_bf16 v[28:31], v[228:231], v[164:167], v[28:31]
    ds_read_b128 v[228:231], v249 offset:0
    s_waitcnt lgkmcnt(3)
    v_mfma_f32_16x16x32_bf16 v[0:3], v[212:215], v[168:171], v[0:3]
    v_add_u32 v251, s28, v251
    v_mfma_f32_16x16x32_bf16 v[8:11], v[212:215], v[176:179], v[8:11]
    ds_read_b128 v[212:215], v249 offset:6144
    v_mfma_f32_16x16x32_bf16 v[4:7], v[216:219], v[168:171], v[4:7]
    s_add_u32 s37, s37, 24576
    s_cmp_eq_u32 s37, 147584
    v_mfma_f32_16x16x32_bf16 v[12:15], v[216:219], v[176:179], v[12:15]
    ds_read_b128 v[216:219], v249 offset:12288
    s_waitcnt lgkmcnt(3)
    v_mfma_f32_16x16x32_bf16 v[16:19], v[220:223], v[168:171], v[16:19]
    s_cselect_b32 s37, 128, s37
    s_cselect_b32 s28, s29, 24576
    v_mfma_f32_16x16x32_bf16 v[24:27], v[220:223], v[176:179], v[24:27]
    ds_read_b128 v[220:223], v249 offset:18432
    v_mfma_f32_16x16x32_bf16 v[20:23], v[224:227], v[168:171], v[20:23]
    v_mfma_f32_16x16x32_bf16 v[28:31], v[224:227], v[176:179], v[28:31]
    s_cmp_ge_u32 s80, 3
    s_cbranch_scc1 L_tg52
L_tb52:
    s_barrier
    ds_read_b128 v[224:227], v251 offset:0
    s_waitcnt lgkmcnt(3)
    v_mfma_f32_16x16x32_bf16 v[32:35], v[228:231], v[128:131], 0
    s_sub_u32 m0, s36, 12288
    s_add_u32 s41, s34, 36864
    v_mfma_f32_16x16x32_bf16 v[40:43], v[228:231], v[132:135], 0
    ds_read_b128 v[228:231], v251 offset:6144
    s_waitcnt vmcnt(5)
    buffer_load_dwordx4 v244, s[20:23], s41 offen nt lds
    v_mfma_f32_16x16x32_bf16 v[36:39], v[212:215], v[128:131], 0
    s_waitcnt vmcnt(5)
    buffer_load_dwordx4 v245, s[20:23], s41 offen offset:1024 nt lds
    v_mfma_f32_16x16x32_bf16 v[44:47], v[212:215], v[132:135], 0
    ds_read_b128 v[212:215], v251 offset:12288
    s_waitcnt lgkmcnt(3)
    v_mfma_f32_16x16x32_bf16 v[48:51], v[216:219], v[128:131], 0
    s_waitcnt vmcnt(5)
    buffer_load_dwordx4 v246, s[20:23], s41 offen offset:2048 nt lds
    v_mfma_f32_16x16x32_bf16 v[56:59], v[216:219], v[132:135], 0
    ds_read_b128 v[216:219], v251 offset:18432
    v_mfma_f32_16x16x32_bf16 v[52:55], v[220:223], v[128:131], 0
    v_max_f32 v238, v0, v1
    v_mfma_f32_16x16x32_bf16 v[60:63], v[220:223], v[132:135], 0
    ds_read_b128 v[220:223], v249 offset:128
    s_waitcnt lgkmcnt(3)
    v_mfma_f32_16x16x32_bf16 v[32:35], v[224:227], v[136:139], v[32:35]
    v_max_f32 v239, v8, v9
    v_mfma_f32_16x16x32_bf16 v[40:43], v[224:227], v[144:147], v[40:43]
    ds_read_b128 v[224:227], v249 offset:6272
    v_mfma_f32_16x16x32_bf16 v[36:39], v[228:231], v[136:139], v[36:39]
    v_max3_f32 v238, v238, v2, v3
    v_mfma_f32_16x16x32_bf16 v[44:47], v[228:231], v[144:147], v[44:47]
    ds_read_b128 v[228:231], v249 offset:12416
    s_waitcnt lgkmcnt(3)
    v_mfma_f32_16x16x32_bf16 v[48:51], v[212:215], v[136:139], v[48:51]
    v_max3_f32 v239, v239, v10, v11
    v_mfma_f32_16x16x32_bf16 v[56:59], v[212:215], v[144:147], v[56:59]
    ds_read_b128 v[212:215], v249 offset:18560
    v_mfma_f32_16x16x32_bf16 v[52:55], v[216:219], v[136:139], v[52:55]
    v_mfma_f32_16x16x32_bf16 v[60:63], v[216:219], v[144:147], v[60:63]
    ds_read_b128 v[216:219], v251 offset:128
    s_waitcnt lgkmcnt(3)
    v_mfma_f32_16x16x32_bf16 v[32:35], v[220:223], v[140:143], v[32:35]
    v_max3_f32 v238, v238, v4, v5
    v_mfma_f32_16x16x32_bf16 v[40:43], v[220:223], v[148:151], v[40:43]
    ds_read_b128 v[220:223], v251 offset:6272
    v_mfma_f32_16x16x32_bf16 v[36:39], v[224:227], v[140:143], v[36:39]
    v_max3_f32 v239, v239, v12, v13
    v_mfma_f32_16x16x32_bf16 v[44:47], v[224:227], v[148:151], v[44:47]
    ds_read_b128 v[224:227], v251 offset:12416
    s_waitcnt lgkmcnt(3)
    v_mfma_f32_16x16x32_bf16 v[48:51], v[228:231], v[140:143], v[48:51]
    s_cmp_eq_u32 s38, 1
    s_cbranch_scc0 L_c53
    s_waitcnt vmcnt(5)
    buffer_store_dwordx4 v[96:99], v253, s[24:27], s44 offen offset:128 sc1
L_c53:
    v_mfma_f32_16x16x32_bf16 v[56:59], v[228:231], v[148:151], v[56:59]
    ds_read_b128 v[228:231], v251 offset:18560
    v_max3_f32 v238, v238, v6, v7
    v_mfma_f32_16x16x32_bf16 v[52:55], v[212:215], v[140:143], v[52:55]
    v_max3_f32 v239, v239, v14, v15
    v_mfma_f32_16x16x32_bf16 v[60:63], v[212:215], v[148:151], v[60:63]
    ds_read_b128 v[212:215], v249 offset:256
    s_waitcnt lgkmcnt(3)
    v_mfma_f32_16x16x32_bf16 v[32:35], v[216:219], v[152:155], v[32:35]
    v_mfma_f32_16x16x32_bf16 v[40:43], v[216:219], v[160:163], v[40:43]
    ds_read_b128 v[216:219], v249 offset:6400
    v_mfma_f32_16x16x32_bf16 v[36:39], v[220:223], v[152:155], v[36:39]
    v_max3_f32 v238, v238, v16, v17
    v_mfma_f32_16x16x32_bf16 v[44:47], v[220:223], v[160:163], v[44:47]
    ds_read_b128 v[220:223], v249 offset:12544
    s_waitcnt lgkmcnt(3)
    v_mfma_f32_16x16x32_bf16 v[48:51], v[224:227], v[152:155], v[48:51]
    v_max3_f32 v239, v239, v24, v25
    v_mfma_f32_16x16x32_bf16 v[56:59], v[224:227], v[160:163], v[56:59]
    ds_read_b128 v[224:227], v249 offset:18688
    v_mfma_f32_16x16x32_bf16 v[52:55], v[228:231], v[152:155], v[52:55]
    v_max3_f32 v238, v238, v18, v19
    v_mfma_f32_16x16x32_bf16 v[60:63], v[228:231], v[160:163], v[60:63]
    ds_read_b128 v[228:231], v251 offset:256
    s_waitcnt lgkmcnt(3)
    v_mfma_f32_16x16x32_bf16 v[32:35], v[212:215], v[156:159], v[32:35]
    v_add_u32 v249, s28, v249
    v_max3_f32 v239, v239, v26, v27
    v_mfma_f32_16x16x32_bf16 v[40:43], v[212:215], v[164:167], v[40:43]
    ds_read_b128 v[212:215], v251 offset:6400
    v_mfma_f32_16x16x32_bf16 v[36:39], v[216:219], v[156:159], v[36:39]
    v_mfma_f32_16x16x32_bf16 v[44:47], v[216:219], v[164:167], v[44:47]
    ds_read_b128 v[216:219], v251 offset:12544
    s_waitcnt lgkmcnt(3)
    v_mfma_f32_16x16x32_bf16 v[48:51], v[220:223], v[156:159], v[48:51]
    v_max3_f32 v238, v238, v20, v21
    v_mfma_f32_16x16x32_bf16 v[56:59], v[220:223], v[164:167], v[56:59]
    ds_read_b128 v[220:223], v251 offset:18688
    v_mfma_f32_16x16x32_bf16 v[52:55], v[224:227], v[156:159], v[52:55]
    v_max3_f32 v239, v239, v28, v29
    v_mfma_f32_16x16x32_bf16 v[60:63], v[224:227], v[164:167], v[60:63]
    ds_read_b128 v[224:227], v249 offset:0
    s_waitcnt lgkmcnt(3)
    v_mfma_f32_16x16x32_bf16 v[32:35], v[228:231], v[168:171], v[32:35]
    v_add_u32 v251, s28, v251
    v_max3_f32 v238, v238, v22, v23
    v_mfma_f32_16x16x32_bf16 v[40:43], v[228:231], v[176:179], v[40:43]
    ds_read_b128 v[228:231], v249 offset:6144
    v_mfma_f32_16x16x32_bf16 v[36:39], v[212:215], v[168:171], v[36:39]
    s_add_u32 s37, s37, 24576
    s_cmp_eq_u32 s37, 147584
    v_mfma_f32_16x16x32_bf16 v[44:47], v[212:215], v[176:179], v[44:47]
    ds_read_b128 v[212:215], v249 offset:12288
    s_waitcnt lgkmcnt(3)
    v_mfma_f32_16x16x32_bf16 v[48:51], v[216:219], v[168:171], v[48:51]
    s_cselect_b32 s37, 128, s37
    s_cselect_b32 s28, s29, 24576
    v_mfma_f32_16x16x32_bf16 v[56:59], v[216:219], v[176:179], v[56:59]
    ds_read_b128 v[216:219], v249 offset:18432
    v_max3_f32 v239, v239, v30, v31
    v_mfma_f32_16x16x32_bf16 v[52:55], v[220:223], v[168:171], v[52:55]
    v_mfma_f32_16x16x32_bf16 v[60:63], v[220:223], v[176:179], v[60:63]
    s_cmp_ge_u32 s80, 2
    s_cbranch_scc1 L_tg54
L_tb54:
    s_barrier
    ds_read_b128 v[220:223], v251 offset:0
    s_waitcnt lgkmcnt(3)
    v_mfma_f32_16x16x32_bf16 v[64:67], v[224:227], v[128:131], 0
    s_mov_b32 m0, s36
    s_add_u32 s41, s34, 49152
    v_mfma_f32_16x16x32_bf16 v[72:75], v[224:227], v[132:135], 0
    ds_read_b128 v[224:227], v251 offset:6144
    s_waitcnt vmcnt(5)
    buffer_load_dwordx4 v244, s[20:23], s41 offen nt lds
    v_mfma_f32_16x16x32_bf16 v[68:71], v[228:231], v[128:131], 0
    s_waitcnt vmcnt(5)
    buffer_load_dwordx4 v245, s[20:23], s41 offen offset:1024 nt lds
    v_mfma_f32_16x16x32_bf16 v[76:79], v[228:231], v[132:135], 0
    ds_read_b128 v[228:231], v251 offset:12288
    s_waitcnt lgkmcnt(3)
    v_mfma_f32_16x16x32_bf16 v[80:83], v[212:215], v[128:131], 0
    s_waitcnt vmcnt(5)
    buffer_load_dwordx4 v246, s[20:23], s41 offen offset:2048 nt lds
    v_mfma_f32_16x16x32_bf16 v[88:91], v[212:215], v[132:135], 0
    ds_read_b128 v[212:215], v251 offset:18432
    s_add_u32 s36, s36, 24576
    v_mfma_f32_16x16x32_bf16 v[84:87], v[216:219], v[128:131], 0
    s_cmp_eq_u32 s36, s45
    s_cselect_b32 s36, s33, s36
    v_mfma_f32_16x16x32_bf16 v[92:95], v[216:219], v[132:135], 0
    ds_read_b128 v[216:219], v249 offset:128
    s_waitcnt lgkmcnt(3)
    v_mfma_f32_16x16x32_bf16 v[64:67], v[220:223], v[136:139], v[64:67]
    v_max3_f32 v238, v238, v32, v33
    v_max3_f32 v239, v239, v40, v41
    v_mfma_f32_16x16x32_bf16 v[72:75], v[220:223], v[144:147], v[72:75]
    ds_read_b128 v[220:223], v249 offset:6272
    v_mfma_f32_16x16x32_bf16 v[68:71], v[224:227], v[136:139], v[68:71]
    v_max3_f32 v238, v238, v34, v35
    v_mfma_f32_16x16x32_bf16 v[76:79], v[224:227], v[144:147], v[76:79]
    ds_read_b128 v[224:227], v249 offset:12416
    s_waitcnt lgkmcnt(3)
    v_mfma_f32_16x16x32_bf16 v[80:83], v[228:231], v[136:139], v[80:83]
    v_max3_f32 v239, v239, v42, v43
    v_mfma_f32_16x16x32_bf16 v[88:91], v[228:231], v[144:147], v[88:91]
    ds_read_b128 v[228:231], v249 offset:18560
    v_mfma_f32_16x16x32_bf16 v[84:87], v[212:215], v[136:139], v[84:87]
    v_mfma_f32_16x16x32_bf16 v[92:95], v[212:215], v[144:147], v[92:95]
    ds_read_b128 v[212:215], v251 offset:128
    s_waitcnt lgkmcnt(3)
    v_mfma_f32_16x16x32_bf16 v[64:67], v[216:219], v[140:143], v[64:67]
    v_max3_f32 v238, v238, v36, v37
    v_mfma_f32_16x16x32_bf16 v[72:75], v[216:219], v[148:151], v[72:75]
    ds_read_b128 v[216:219], v251 offset:6272
    v_mfma_f32_16x16x32_bf16 v[68:71], v[220:223], v[140:143], v[68:71]
    v_max3_f32 v239, v239, v44, v45
    v_mfma_f32_16x16x32_bf16 v[76:79], v[220:223], v[148:151], v[76:79]
    ds_read_b128 v[220:223], v251 offset:12416
    s_waitcnt lgkmcnt(3)
    v_mfma_f32_16x16x32_bf16 v[80:83], v[224:227], v[140:143], v[80:83]
    s_cmp_eq_u32 s38, 1
    s_cbranch_scc0 L_c55
    s_waitcnt vmcnt(5)
    buffer_store_dwordx4 v[108:111], v253, s[24:27], s44 offen offset:3200 sc1
L_c55:
    v_mfma_f32_16x16x32_bf16 v[88:91], v[224:227], v[148:151], v[88:91]
    ds_read_b128 v[224:227], v251 offset:18560
    v_max3_f32 v238, v238, v38, v39
    v_mfma_f32_16x16x32_bf16 v[84:87], v[228:231], v[140:143], v[84:87]
    v_max3_f32 v239, v239, v46, v47
    v_mfma_f32_16x16x32_bf16 v[92:95], v[228:231], v[148:151], v[92:95]
    ds_read_b128 v[228:231], v249 offset:256
    s_waitcnt lgkmcnt(3)
    v_mfma_f32_16x16x32_bf16 v[64:67], v[212:215], v[152:155], v[64:67]
    v_mfma_f32_16x16x32_bf16 v[72:75], v[212:215], v[160:163], v[72:75]
    ds_read_b128 v[212:215], v249 offset:6400
    v_mfma_f32_16x16x32_bf16 v[68:71], v[216:219], v[152:155], v[68:71]
    v_max3_f32 v238, v238, v48, v49
    v_mfma_f32_16x16x32_bf16 v[76:79], v[216:219], v[160:163], v[76:79]
    ds_read_b128 v[216:219], v249 offset:12544
    s_waitcnt lgkmcnt(3)
    v_mfma_f32_16x16x32_bf16 v[80:83], v[220:223], v[152:155], v[80:83]
    v_max3_f32 v239, v239, v56, v57
    v_mfma_f32_16x16x32_bf16 v[88:91], v[220:223], v[160:163], v[88:91]
    ds_read_b128 v[220:223], v249 offset:18688
    v_mfma_f32_16x16x32_bf16 v[84:87], v[224:227], v[152:155], v[84:87]
    v_max3_f32 v238, v238, v50, v51
    v_mfma_f32_16x16x32_bf16 v[92:95], v[224:227], v[160:163], v[92:95]
    ds_read_b128 v[224:227], v251 offset:256
    s_waitcnt lgkmcnt(3)
    v_mfma_f32_16x16x32_bf16 v[64:67], v[228:231], v[156:159], v[64:67]
    v_add_u32 v249, s28, v249
    v_max3_f32 v239, v239, v58, v59
    v_mfma_f32_16x16x32_bf16 v[72:75], v[228:231], v[164:167], v[72:75]
    ds_read_b128 v[228:231], v251 offset:6400
    v_mfma_f32_16x16x32_bf16 v[68:71], v[212:215], v[156:159], v[68:71]
    v_mfma_f32_16x16x32_bf16 v[76:79], v[212:215], v[164:167], v[76:79]
    ds_read_b128 v[212:215], v251 offset:12544
    s_waitcnt lgkmcnt(3)
    v_mfma_f32_16x16x32_bf16 v[80:83], v[216:219], v[156:159], v[80:83]
    v_max3_f32 v238, v238, v52, v53
    v_mfma_f32_16x16x32_bf16 v[88:91], v[216:219], v[164:167], v[88:91]
    ds_read_b128 v[216:219], v251 offset:18688
    v_mfma_f32_16x16x32_bf16 v[84:87], v[220:223], v[156:159], v[84:87]
    v_max3_f32 v239, v239, v60, v61
    v_mfma_f32_16x16x32_bf16 v[92:95], v[220:223], v[164:167], v[92:95]
    ds_read_b128 v[220:223], v249 offset:0
    s_waitcnt lgkmcnt(3)
    v_mfma_f32_16x16x32_bf16 v[64:67], v[224:227], v[168:171], v[64:67]
    v_add_u32 v251, s28, v251
    v_max3_f32 v238, v238, v54, v55
    v_mfma_f32_16x16x32_bf16 v[72:75], v[224:227], v[176:179], v[72:75]
    ds_read_b128 v[224:227], v249 offset:6144
    v_mfma_f32_16x16x32_bf16 v[68:71], v[228:231], v[168:171], v[68:71]
    s_add_u32 s37, s37, 24576
    s_cmp_eq_u32 s37, 147584
    v_mfma_f32_16x16x32_bf16 v[76:79], v[228:231], v[176:179], v[76:79]
    ds_read_b128 v[228:231], v249 offset:12288
    s_waitcnt lgkmcnt(3)
    v_mfma_f32_16x16x32_bf16 v[80:83], v[212:215], v[168:171], v[80:83]
    s_cselect_b32 s37, 128, s37
    s_cselect_b32 s28, s29, 24576
    v_mfma_f32_16x16x32_bf16 v[88:91], v[212:215], v[176:179], v[88:91]
    ds_read_b128 v[212:215], v249 offset:18432
    v_max3_f32 v239, v239, v62, v63
    v_mfma_f32_16x16x32_bf16 v[84:87], v[216:219], v[168:171], v[84:87]
    v_mfma_f32_16x16x32_bf16 v[92:95], v[216:219], v[176:179], v[92:95]
    s_cmp_ge_u32 s80, 3
    s_cbranch_scc1 L_tg56
L_tb56:
    s_barrier
    ds_read_b128 v[216:219], v251 offset:0
    s_waitcnt lgkmcnt(3)
    v_mfma_f32_16x16x32_bf16 v[96:99], v[220:223], v[128:131], 0
    ds_read_b32 v254, v247
    v_mfma_f32_16x16x32_bf16 v[104:107], v[220:223], v[132:135], 0
    ds_read_b128 v[220:223], v251 offset:6144
    v_mfma_f32_16x16x32_bf16 v[100:103], v[224:227], v[128:131], 0
    v_mfma_f32_16x16x32_bf16 v[108:111], v[224:227], v[132:135], 0
    ds_read_b128 v[224:227], v251 offset:12288
    s_waitcnt lgkmcnt(4)
    v_mfma_f32_16x16x32_bf16 v[112:115], v[228:231], v[128:131], 0
    v_mfma_f32_16x16x32_bf16 v[120:123], v[228:231], v[132:135], 0
    ds_read_b128 v[228:231], v251 offset:18432
    v_mfma_f32_16x16x32_bf16 v[116:119], v[212:215], v[128:131], 0
    v_max3_f32 v238, v238, v64, v65
    v_mfma_f32_16x16x32_bf16 v[124:127], v[212:215], v[132:135], 0
    ds_read_b128 v[212:215], v249 offset:128
    s_waitcnt lgkmcnt(3)
    v_mfma_f32_16x16x32_bf16 v[96:99], v[216:219], v[136:139], v[96:99]
    v_max3_f32 v239, v239, v72, v73
    v_mfma_f32_16x16x32_bf16 v[104:107], v[216:219], v[144:147], v[104:107]
    ds_read_b128 v[216:219], v249 offset:6272
    v_mfma_f32_16x16x32_bf16 v[100:103], v[220:223], v[136:139], v[100:103]
    v_max3_f32 v238, v238, v66, v67
    v_mfma_f32_16x16x32_bf16 v[108:111], v[220:223], v[144:147], v[108:111]
    ds_read_b128 v[220:223], v249 offset:12416
    s_waitcnt lgkmcnt(3)
    v_mfma_f32_16x16x32_bf16 v[112:115], v[224:227], v[136:139], v[112:115]
    v_max3_f32 v239, v239, v74, v75
    v_mfma_f32_16x16x32_bf16 v[120:123], v[224:227], v[144:147], v[120:123]
    ds_read_b128 v[224:227], v249 offset:18560
    v_mfma_f32_16x16x32_bf16 v[116:119], v[228:231], v[136:139], v[116:119]
    s_sub_u32 m0, s36, 12288
    s_add_u32 s41, s34, 61440
    v_mfma_f32_16x16x32_bf16 v[124:127], v[228:231], v[144:147], v[124:127]
    ds_read_b128 v[228:231], v251 offset:128
    s_waitcnt lgkmcnt(3)
    v_mfma_f32_16x16x32_bf16 v[96:99], v[212:215], v[140:143], v[96:99]
    s_waitcnt vmcnt(5)
    buffer_load_dwordx4 v244, s[20:23], s41 offen nt lds
    v_mfma_f32_16x16x32_bf16 v[104:107], v[212:215], v[148:151], v[104:107]
    ds_read_b128 v[212:215], v251 offset:6272
    s_waitcnt vmcnt(5)
    buffer_load_dwordx4 v245, s[20:23], s41 offen offset:1024 nt lds
    v_mfma_f32_16x16x32_bf16 v[100:103], v[216:219], v[140:143], v[100:103]
    s_waitcnt vmcnt(5)
    buffer_load_dwordx4 v246, s[20:23], s41 offen offset:2048 nt lds
    v_mfma_f32_16x16x32_bf16 v[108:111], v[216:219], v[148:151], v[108:111]
    ds_read_b128 v[216:219], v251 offset:12416
    s_waitcnt lgkmcnt(3)
    v_mfma_f32_16x16x32_bf16 v[112:115], v[220:223], v[140:143], v[112:115]
    v_max3_f32 v238, v238, v68, v69
    v_max3_f32 v239, v239, v76, v77
    v_mfma_f32_16x16x32_bf16 v[120:123], v[220:223], v[148:151], v[120:123]
    ds_read_b128 v[220:223], v251 offset:18560
    v_max3_f32 v238, v238, v70, v71
    v_mfma_f32_16x16x32_bf16 v[116:119], v[224:227], v[140:143], v[116:119]
    v_max3_f32 v239, v239, v78, v79
    v_mfma_f32_16x16x32_bf16 v[124:127], v[224:227], v[148:151], v[124:127]
    ds_read_b128 v[224:227], v249 offset:256
    s_waitcnt lgkmcnt(3)
    v_mfma_f32_16x16x32_bf16 v[96:99], v[228:231], v[152:155], v[96:99]
    v_mfma_f32_16x16x32_bf16 v[104:107], v[228:231], v[160:163], v[104:107]
    ds_read_b128 v[228:231], v249 offset:6400
    v_mfma_f32_16x16x32_bf16 v[100:103], v[212:215], v[152:155], v[100:103]
    v_max3_f32 v238, v238, v80, v81
    v_mfma_f32_16x16x32_bf16 v[108:111], v[212:215], v[160:163], v[108:111]
    ds_read_b128 v[212:215], v249 offset:12544
    s_waitcnt lgkmcnt(3)
    v_mfma_f32_16x16x32_bf16 v[112:115], v[216:219], v[152:155], v[112:115]
    v_readfirstlane_b32 s81, v254
    v_mfma_f32_16x16x32_bf16 v[120:123], v[216:219], v[160:163], v[120:123]
    ds_read_b128 v[216:219], v249 offset:18688
    s_cmp_lt_i32 s81, 10
    v_mfma_f32_16x16x32_bf16 v[116:119], v[220:223], v[152:155], v[116:119]
    s_cselect_b32 s80, 1, 0
    s_cmp_lt_i32 s81, 6
    v_mfma_f32_16x16x32_bf16 v[124:127], v[220:223], v[160:163], v[124:127]
    ds_read_b128 v[220:223], v251 offset:256
    s_waitcnt lgkmcnt(3)
    v_mfma_f32_16x16x32_bf16 v[96:99], v[224:227], v[156:159], v[96:99]
    s_cselect_b32 s80, 2, s80
    s_cmp_lt_i32 s81, 3
    v_mfma_f32_16x16x32_bf16 v[104:107], v[224:227], v[164:167], v[104:107]
    ds_read_b128 v[224:227], v251 offset:6400
    s_cselect_b32 s80, 3, s80
    v_mfma_f32_16x16x32_bf16 v[100:103], v[228:231], v[156:159], v[100:103]
    s_cmp_eq_u32 s38, 1
    s_cselect_b32 s80, 0, s80
    v_mfma_f32_16x16x32_bf16 v[108:111], v[228:231], v[164:167], v[108:111]
    ds_read_b128 v[228:231], v251 offset:12544
    s_waitcnt lgkmcnt(3)
    v_mfma_f32_16x16x32_bf16 v[112:115], v[212:215], v[156:159], v[112:115]
    s_cmp_le_u32 s38, 1
    s_cselect_b32 s81, 2, 9
    v_mfma_f32_16x16x32_bf16 v[120:123], v[212:215], v[164:167], v[120:123]
    ds_read_b128 v[212:215], v251 offset:18688
    s_min_u32 s80, s80, s81
    v_mfma_f32_16x16x32_bf16 v[116:119], v[216:219], v[156:159], v[116:119]
    s_cmp_le_u32 s38, 1
    s_cselect_b32 s81, 1, 9
    v_mfma_f32_16x16x32_bf16 v[124:127], v[216:219], v[164:167], v[124:127]
    s_min_u32 s80, s80, s81
    s_waitcnt lgkmcnt(2)
    v_mfma_f32_16x16x32_bf16 v[96:99], v[220:223], v[168:171], v[96:99]
    v_max3_f32 v239, v239, v88, v89
    v_max3_f32 v238, v238, v82, v83
    v_mfma_f32_16x16x32_bf16 v[104:107], v[220:223], v[176:179], v[104:107]
    v_max3_f32 v239, v239, v90, v91
    v_max3_f32 v238, v238, v84, v85
    v_mfma_f32_16x16x32_bf16 v[100:103], v[224:227], v[168:171], v[100:103]
    v_max3_f32 v239, v239, v92, v93
    v_max3_f32 v238, v238, v86, v87
    v_mfma_f32_16x16x32_bf16 v[108:111], v[224:227], v[176:179], v[108:111]
    v_max3_f32 v239, v239, v94, v95
    s_waitcnt lgkmcnt(0)
    v_mfma_f32_16x16x32_bf16 v[112:115], v[228:231], v[168:171], v[112:115]
    v_mfma_f32_16x16x32_bf16 v[120:123], v[228:231], v[176:179], v[120:123]
    v_mfma_f32_16x16x32_bf16 v[116:119], v[212:215], v[168:171], v[116:119]
    v_mfma_f32_16x16x32_bf16 v[124:127], v[212:215], v[176:179], v[124:127]
    s_nop 7
    s_nop 2
    v_max3_f32 v238, v238, v96, v97
    v_max3_f32 v239, v239, v104, v105
    v_max3_f32 v238, v238, v98, v99
    v_max3_f32 v239, v239, v106, v107
    v_max3_f32 v238, v238, v100, v101
    v_max3_f32 v239, v239, v108, v109
    v_max3_f32 v238, v238, v102, v103
    v_max3_f32 v239, v239, v110, v111
    v_max3_f32 v238, v238, v112, v113
    v_max3_f32 v239, v239, v120, v121
    v_max3_f32 v238, v238, v114, v115
    v_max3_f32 v239, v239, v122, v123
    v_max3_f32 v238, v238, v116, v117
    v_max3_f32 v239, v239, v124, v125
    v_max3_f32 v238, v238, v118, v119
    v_max3_f32 v239, v239, v126, v127
    s_nop 1
    v_permlane32_swap_b32 v238, v239
    v_max_f32 v238, v238, v239
    v_mov_b32 v239, v238
    s_nop 1
    v_permlane16_swap_b32 v238, v239
    v_max_f32 v238, v238, v239
    v_mul_f32 v240, s40, v238
    v_mov_b32 v241, v240
    s_nop 1
    v_permlane32_swap_b32 v240, v241
    v_fma_f32 v0, v0, s39, v240
    v_fma_f32 v1, v1, s39, v240
    v_fma_f32 v2, v2, s39, v240
    s_cmp_ge_u32 s80, 1
    s_cbranch_scc1 L_tg57
L_tb57:
    s_barrier
    s_mov_b32 m0, s36
    s_add_u32 s41, s34, 73728
    s_waitcnt vmcnt(5)
    buffer_load_dwordx4 v244, s[20:23], s41 offen nt lds
    s_waitcnt vmcnt(5)
    buffer_load_dwordx4 v245, s[20:23], s41 offen offset:1024 nt lds
    s_waitcnt vmcnt(5)
    buffer_load_dwordx4 v246, s[20:23], s41 offen offset:2048 nt lds
    s_add_u32 s36, s36, 73728
    s_cmp_ge_u32 s36, s45
    s_cselect_b32 s41, 147456, 0
    s_sub_u32 s36, s36, s41
    v_fma_f32 v3, v3, s39, v240
    v_exp_f32 v0, v0
    v_exp_f32 v1, v1
    v_fma_f32 v4, v4, s39, v240
    v_fma_f32 v5, v5, s39, v240
    v_exp_f32 v2, v2
    v_exp_f32 v3, v3
    v_cvt_pk_bf16_f32 v0, v0, v1
    v_fma_f32 v6, v6, s39, v240
    v_fma_f32 v7, v7, s39, v240
    v_exp_f32 v4, v4
    v_exp_f32 v5, v5
    v_cvt_pk_bf16_f32 v1, v2, v3
    v_fma_f32 v8, v8, s39, v241
    v_fma_f32 v9, v9, s39, v241
    v_exp_f32 v6, v6
    v_exp_f32 v7, v7
    v_cvt_pk_bf16_f32 v2, v4, v5
    v_fma_f32 v10, v10, s39, v241
    v_fma_f32 v11, v11, s39, v241
    v_exp_f32 v8, v8
    v_exp_f32 v9, v9
    v_cvt_pk_bf16_f32 v3, v6, v7
    v_fma_f32 v12, v12, s39, v241
    v_fma_f32 v13, v13, s39, v241
    v_exp_f32 v10, v10
    v_exp_f32 v11, v11
    v_cvt_pk_bf16_f32 v4, v8, v9
    v_fma_f32 v14, v14, s39, v241
    v_fma_f32 v15, v15, s39, v241
    v_exp_f32 v12, v12
    v_exp_f32 v13, v13
    v_cvt_pk_bf16_f32 v5, v10, v11
    v_fma_f32 v16, v16, s39, v240
    v_fma_f32 v17, v17, s39, v240
    v_exp_f32 v14, v14
    v_exp_f32 v15, v15
    v_cvt_pk_bf16_f32 v6, v12, v13
    v_fma_f32 v18, v18, s39, v240
    v_fma_f32 v19, v19, s39, v240
    v_exp_f32 v16, v16
    v_exp_f32 v17, v17
    v_cvt_pk_bf16_f32 v7, v14, v15
    v_fma_f32 v20, v20, s39, v240
    v_fma_f32 v21, v21, s39, v240
    v_exp_f32 v18, v18
    v_exp_f32 v19, v19
    v_cvt_pk_bf16_f32 v8, v16, v17
    v_fma_f32 v22, v22, s39, v240
    v_fma_f32 v23, v23, s39, v240
    v_exp_f32 v20, v20
    v_exp_f32 v21, v21
    v_cvt_pk_bf16_f32 v9, v18, v19
    v_fma_f32 v24, v24, s39, v241
    v_fma_f32 v25, v25, s39, v241
    v_exp_f32 v22, v22
    v_exp_f32 v23, v23
    v_cvt_pk_bf16_f32 v10, v20, v21
    v_fma_f32 v26, v26, s39, v241
    v_fma_f32 v27, v27, s39, v241
    v_exp_f32 v24, v24
    v_exp_f32 v25, v25
    v_cvt_pk_bf16_f32 v11, v22, v23
    v_fma_f32 v28, v28, s39, v241
    v_fma_f32 v29, v29, s39, v241
    v_exp_f32 v26, v26
    v_exp_f32 v27, v27
    v_cvt_pk_bf16_f32 v12, v24, v25
    v_fma_f32 v30, v30, s39, v241
    v_fma_f32 v31, v31, s39, v241
    v_exp_f32 v28, v28
    v_exp_f32 v29, v29
    v_cvt_pk_bf16_f32 v13, v26, v27
    v_fma_f32 v32, v32, s39, v240
    v_fma_f32 v33, v33, s39, v240
    v_exp_f32 v30, v30
    v_exp_f32 v31, v31
    v_cvt_pk_bf16_f32 v14, v28, v29
    v_fma_f32 v34, v34, s39, v240
    v_fma_f32 v35, v35, s39, v240
    s_cmp_ge_u32 s80, 3
    s_cbranch_scc1 L_tg58
L_tb58:
    s_barrier
    s_cmp_eq_u32 s38, 1
    s_cbranch_scc1 L_c59
    s_waitcnt vmcnt(5)
    buffer_load_dwordx4 v[132:135], v253, s[12:15], s35 offen nt
L_c59:
    v_exp_f32 v32, v32
    v_exp_f32 v33, v33
    v_cvt_pk_bf16_f32 v15, v30, v31
    v_fma_f32 v36, v36, s39, v240
    v_fma_f32 v37, v37, s39, v240
    v_exp_f32 v34, v34
    v_exp_f32 v35, v35
    v_cvt_pk_bf16_f32 v16, v32, v33
    v_fma_f32 v38, v38, s39, v240
    v_fma_f32 v39, v39, s39, v240
    v_exp_f32 v36, v36
    v_exp_f32 v37, v37
    v_cvt_pk_bf16_f32 v17, v34, v35
    v_fma_f32 v40, v40, s39, v241
    v_fma_f32 v41, v41, s39, v241
    v_exp_f32 v38, v38
    v_exp_f32 v39, v39
    v_cvt_pk_bf16_f32 v18, v36, v37
    v_fma_f32 v42, v42, s39, v241
    s_cmp_eq_u32 s38, 1
    s_cbranch_scc1 L_c60
    s_waitcnt vmcnt(5)
    buffer_load_dwordx4 v[136:139], v253, s[12:15], s35 offen offset:3072 nt
L_c60:
    v_fma_f32 v43, v43, s39, v241
    v_exp_f32 v40, v40
    v_exp_f32 v41, v41
    v_cvt_pk_bf16_f32 v19, v38, v39
    v_fma_f32 v44, v44, s39, v241
    v_fma_f32 v45, v45, s39, v241
    v_exp_f32 v42, v42
    v_exp_f32 v43, v43
    v_cvt_pk_bf16_f32 v20, v40, v41
    v_fma_f32 v46, v46, s39, v241
    v_fma_f32 v47, v47, s39, v241
    v_exp_f32 v44, v44
    v_exp_f32 v45, v45
    v_cvt_pk_bf16_f32 v21, v42, v43
    v_fma_f32 v48, v48, s39, v240
    v_fma_f32 v49, v49, s39, v240
    v_exp_f32 v46, v46
    v_exp_f32 v47, v47
    v_cvt_pk_bf16_f32 v22, v44, v45
    v_fma_f32 v50, v50, s39, v240
    s_cmp_eq_u32 s38, 1
    s_cbranch_scc1 L_c61
    s_waitcnt vmcnt(5)
    buffer_load_dwordx4 v[140:143], v253, s[12:15], s42 offen nt
L_c61:
    v_fma_f32 v51, v51, s39, v240
    v_exp_f32 v48, v48
    v_exp_f32 v49, v49
    v_cvt_pk_bf16_f32 v23, v46, v47
    v_fma_f32 v52, v52, s39, v240
    v_fma_f32 v53, v53, s39, v240
    v_exp_f32 v50, v50
    v_exp_f32 v51, v51
    v_cvt_pk_bf16_f32 v24, v48, v49
    v_fma_f32 v54, v54, s39, v240
    v_fma_f32 v55, v55, s39, v240
    v_exp_f32 v52, v52
    v_exp_f32 v53, v53
    v_cvt_pk_bf16_f32 v25, v50, v51
    v_fma_f32 v56, v56, s39, v241
    v_fma_f32 v57, v57, s39, v241
    v_exp_f32 v54, v54
    v_exp_f32 v55, v55
    v_cvt_pk_bf16_f32 v26, v52, v53
    v_fma_f32 v58, v58, s39, v241
    s_cmp_eq_u32 s38, 1
    s_cbranch_scc0 L_c62
    s_waitcnt vmcnt(5)
    buffer_store_dwordx4 v[196:199], v253, s[24:27], s43 offen offset:256 sc1
L_c62:
    v_fma_f32 v59, v59, s39, v241
    v_exp_f32 v56, v56
    v_exp_f32 v57, v57
    v_cvt_pk_bf16_f32 v27, v54, v55
    v_fma_f32 v60, v60, s39, v241
    v_fma_f32 v61, v61, s39, v241
    v_exp_f32 v58, v58
    v_exp_f32 v59, v59
    v_cvt_pk_bf16_f32 v28, v56, v57
    v_fma_f32 v62, v62, s39, v241
    v_fma_f32 v63, v63, s39, v241
    v_exp_f32 v60, v60
    v_exp_f32 v61, v61
    v_cvt_pk_bf16_f32 v29, v58, v59
    v_fma_f32 v64, v64, s39, v240
    v_fma_f32 v65, v65, s39, v240
    v_exp_f32 v62, v62
    v_exp_f32 v63, v63
    v_cvt_pk_bf16_f32 v30, v60, v61
    v_fma_f32 v66, v66, s39, v240
    s_cmp_ge_u32 s80, 2
    s_cbranch_scc1 L_tg63
L_tb63:
    s_barrier
    s_cmp_eq_u32 s38, 1
    s_cbranch_scc1 L_c64
    s_waitcnt vmcnt(5)
    buffer_load_dwordx4 v[144:147], v253, s[12:15], s42 offen offset:3072 nt
L_c64:
    v_fma_f32 v67, v67, s39, v240
    v_exp_f32 v64, v64
    v_exp_f32 v65, v65
    v_cvt_pk_bf16_f32 v31, v62, v63
    v_fma_f32 v68, v68, s39, v240
    v_fma_f32 v69, v69, s39, v240
    v_exp_f32 v66, v66
    v_exp_f32 v67, v67
    v_cvt_pk_bf16_f32 v32, v64, v65
    v_fma_f32 v70, v70, s39, v240
    v_fma_f32 v71, v71, s39, v240
    v_exp_f32 v68, v68
    v_exp_f32 v69, v69
    v_cvt_pk_bf16_f32 v33, v66, v67
    v_fma_f32 v72, v72, s39, v241
    v_fma_f32 v73, v73, s39, v241
    s_cmp_eq_u32 s38, 1
    s_cbranch_scc1 L_c65
    s_waitcnt vmcnt(5)
    buffer_load_dwordx4 v[148:151], v253, s[12:15], s35 offen offset:128 nt
L_c65:
    v_exp_f32 v70, v70
    v_exp_f32 v71, v71
    v_cvt_pk_bf16_f32 v34, v68, v69
    v_fma_f32 v74, v74, s39, v241
    v_fma_f32 v75, v75, s39, v241
    v_exp_f32 v72, v72
    v_exp_f32 v73, v73
    v_cvt_pk_bf16_f32 v35, v70, v71
    v_fma_f32 v76, v76, s39, v241
    v_fma_f32 v77, v77, s39, v241
    v_exp_f32 v74, v74
    v_exp_f32 v75, v75
    v_cvt_pk_bf16_f32 v36, v72, v73
    v_fma_f32 v78, v78, s39, v241
    v_fma_f32 v79, v79, s39, v241
    v_exp_f32 v76, v76
    s_cmp_eq_u32 s38, 1
    s_cbranch_scc1 L_c66
    s_waitcnt vmcnt(5)
    buffer_load_dwordx4 v[152:155], v253, s[12:15], s35 offen offset:3200 nt
L_c66:
    v_exp_f32 v77, v77
    v_cvt_pk_bf16_f32 v37, v74, v75
    v_fma_f32 v80, v80, s39, v240
    v_fma_f32 v81, v81, s39, v240
    v_exp_f32 v78, v78
    v_exp_f32 v79, v79
    v_cvt_pk_bf16_f32 v38, v76, v77
    v_fma_f32 v82, v82, s39, v240
    v_fma_f32 v83, v83, s39, v240
    v_exp_f32 v80, v80
    v_exp_f32 v81, v81
    v_cvt_pk_bf16_f32 v39, v78, v79
    v_fma_f32 v84, v84, s39, v240
    v_fma_f32 v85, v85, s39, v240
    v_exp_f32 v82, v82
    v_exp_f32 v83, v83
    s_cmp_eq_u32 s38, 1
    s_cbranch_scc0 L_c67
    s_waitcnt vmcnt(5)
    buffer_store_dwordx4 v[184:187], v253, s[24:27], s43 offen offset:3328 sc1
L_c67:
    v_cvt_pk_bf16_f32 v40, v80, v81
    v_fma_f32 v86, v86, s39, v240
    v_fma_f32 v87, v87, s39, v240
    v_exp_f32 v84, v84
    v_exp_f32 v85, v85
    v_cvt_pk_bf16_f32 v41, v82, v83
    v_fma_f32 v88, v88, s39, v241
    v_fma_f32 v89, v89, s39, v241
    v_exp_f32 v86, v86
    v_exp_f32 v87, v87
    v_cvt_pk_bf16_f32 v42, v84, v85
    v_fma_f32 v90, v90, s39, v241
    v_fma_f32 v91, v91, s39, v241
    v_exp_f32 v88, v88
    v_exp_f32 v89, v89
    v_cvt_pk_bf16_f32 v43, v86, v87
    s_cmp_eq_u32 s38, 1
    s_cbranch_scc0 L_c68
    s_waitcnt vmcnt(5)
    buffer_store_dwordx4 v[180:183], v253, s[24:27], s44 offen offset:256 sc1
L_c68:
    v_fma_f32 v92, v92, s39, v241
    v_fma_f32 v93, v93, s39, v241
    v_exp_f32 v90, v90
    v_exp_f32 v91, v91
    v_cvt_pk_bf16_f32 v44, v88, v89
    v_fma_f32 v94, v94, s39, v241
    v_fma_f32 v95, v95, s39, v241
    v_exp_f32 v92, v92
    v_exp_f32 v93, v93
    v_cvt_pk_bf16_f32 v45, v90, v91
    v_fma_f32 v96, v96, s39, v240
    v_fma_f32 v97, v97, s39, v240
    v_exp_f32 v94, v94
    v_exp_f32 v95, v95
    v_cvt_pk_bf16_f32 v46, v92, v93
    v_fma_f32 v98, v98, s39, v240
    s_cmp_eq_u32 s38, 1
    s_cbranch_scc0 L_c104
    s_waitcnt vmcnt(3)
L_c104:
    s_cmp_ge_u32 s80, 3
    s_cbranch_scc1 L_tg69
L_tb69:
    s_barrier
    ds_read_b32 v254, v247
    v_fma_f32 v99, v99, s39, v240
    v_exp_f32 v96, v96
    v_exp_f32 v97, v97
    v_cvt_pk_bf16_f32 v47, v94, v95
    v_fma_f32 v100, v100, s39, v240
    v_fma_f32 v101, v101, s39, v240
    v_exp_f32 v98, v98
    v_exp_f32 v99, v99
    v_cvt_pk_bf16_f32 v48, v96, v97
    v_fma_f32 v102, v102, s39, v240
    v_fma_f32 v103, v103, s39, v240
    v_exp_f32 v100, v100
    v_exp_f32 v101, v101
    s_cmp_eq_u32 s38, 1
    s_cbranch_scc1 L_c70
    s_waitcnt vmcnt(5)
    buffer_load_dwordx4 v[156:159], v253, s[12:15], s42 offen offset:128 nt
L_c70:
    v_cvt_pk_bf16_f32 v49, v98, v99
    v_fma_f32 v104, v104, s39, v241
    v_fma_f32 v105, v105, s39, v241
    v_exp_f32 v102, v102
    v_exp_f32 v103, v103
    v_cvt_pk_bf16_f32 v50, v100, v101
    v_fma_f32 v106, v106, s39, v241
    v_fma_f32 v107, v107, s39, v241
    v_exp_f32 v104, v104
    v_exp_f32 v105, v105
    v_cvt_pk_bf16_f32 v51, v102, v103
    v_fma_f32 v108, v108, s39, v241
    v_fma_f32 v109, v109, s39, v241
    s_waitcnt lgkmcnt(0)
    v_readfirstlane_b32 s81, v254
    s_cmp_lt_i32 s81, 10
    s_cselect_b32 s80, 1, 0
    s_cmp_lt_i32 s81, 6
    s_cselect_b32 s80, 2, s80
    s_cmp_lt_i32 s81, 3
    s_cselect_b32 s80, 3, s80
    s_cmp_eq_u32 s38, 1
    s_cselect_b32 s80, 0, s80
    s_cmp_le_u32 s38, 1
    s_cselect_b32 s81, 2, 9
    s_min_u32 s80, s80, s81
    s_cmp_le_u32 s38, 1
    s_cselect_b32 s81, 1, 9
    s_min_u32 s80, s80, s81
    v_exp_f32 v106, v106
    v_exp_f32 v107, v107
    v_cvt_pk_bf16_f32 v52, v104, v105
    v_fma_f32 v110, v110, s39, v241
    v_fma_f32 v111, v111, s39, v241
    v_exp_f32 v108, v108
    v_exp_f32 v109, v109
    v_cvt_pk_bf16_f32 v53, v106, v107
    v_fma_f32 v112, v112, s39, v240
    v_fma_f32 v113, v113, s39, v240
    v_exp_f32 v110, v110
    v_exp_f32 v111, v111
    v_cvt_pk_bf16_f32 v54, v108, v109
    v_fma_f32 v114, v114, s39, v240
    s_cmp_eq_u32 s38, 1
    s_cbranch_scc1 L_c71
    s_waitcnt vmcnt(5)
    buffer_load_dwordx4 v[160:163], v253, s[12:15], s42 offen offset:3200 nt
L_c71:
    v_fma_f32 v115, v115, s39, v240
    v_exp_f32 v112, v112
    v_exp_f32 v113, v113
    v_cvt_pk_bf16_f32 v55, v110, v111
    v_fma_f32 v116, v116, s39, v240
    v_fma_f32 v117, v117, s39, v240
    v_exp_f32 v114, v114
    v_exp_f32 v115, v115
    v_cvt_pk_bf16_f32 v56, v112, v113
    v_fma_f32 v118, v118, s39, v240
    v_fma_f32 v119, v119, s39, v240
    v_exp_f32 v116, v116
    v_exp_f32 v117, v117
    s_cmp_eq_u32 s38, 1
    s_cbranch_scc1 L_c72
    s_waitcnt vmcnt(5)
    buffer_load_dwordx4 v[164:167], v253, s[12:15], s35 offen offset:256 nt
L_c72:
    v_cvt_pk_bf16_f32 v57, v114, v115
    v_fma_f32 v120, v120, s39, v241
    v_fma_f32 v121, v121, s39, v241
    v_exp_f32 v118, v118
    v_exp_f32 v119, v119
    v_cvt_pk_bf16_f32 v58, v116, v117
    v_fma_f32 v122, v122, s39, v241
    v_fma_f32 v123, v123, s39, v241
    v_exp_f32 v120, v120
    v_exp_f32 v121, v121
    v_cvt_pk_bf16_f32 v59, v118, v119
    v_fma_f32 v124, v124, s39, v241
    v_fma_f32 v125, v125, s39, v241
    s_cmp_eq_u32 s38, 1
    s_cbranch_scc0 L_c73
    s_waitcnt vmcnt(5)
    buffer_store_dwordx4 v[192:195], v253, s[24:27], s44 offen offset:3328 sc1
L_c73:
    v_exp_f32 v122, v122
    v_exp_f32 v123, v123
    v_cvt_pk_bf16_f32 v60, v120, v121
    v_fma_f32 v126, v126, s39, v241
    v_fma_f32 v127, v127, s39, v241
    v_exp_f32 v124, v124
    v_exp_f32 v125, v125
    v_cvt_pk_bf16_f32 v61, v122, v123
    v_exp_f32 v126, v126
    v_exp_f32 v127, v127
    v_add_u32 v249, s37, v248
    v_xor_b32 v250, 32, v249
    v_xor_b32 v251, 64, v249
    v_xor_b32 v252, 96, v249
    ds_read_b64_tr_b16 v[212:213], v249 offset:0
    ds_read_b64_tr_b16 v[214:215], v249 offset:6144
    ds_read_b64_tr_b16 v[216:217], v250 offset:0
    ds_read_b64_tr_b16 v[218:219], v250 offset:6144
    ds_read_b64_tr_b16 v[220:221], v251 offset:0
    ds_read_b64_tr_b16 v[222:223], v251 offset:6144
    ds_read_b64_tr_b16 v[224:225], v252 offset:0
    ds_read_b64_tr_b16 v[226:227], v252 offset:6144
    ds_read_b64_tr_b16 v[228:229], v249 offset:128
    ds_read_b64_tr_b16 v[230:231], v249 offset:6272
    s_add_u32 s37, s37, 24576
    s_cmp_eq_u32 s37, 147584
    s_cselect_b32 s37, 128, s37
    s_cselect_b32 s28, s29, 24576
    v_cvt_pk_bf16_f32 v62, v124, v125
    s_nop 0
    v_cvt_pk_bf16_f32 v63, v126, v127
    s_nop 1
    s_cmp_ge_u32 s80, 1
    s_cbranch_scc1 L_tg74
L_tb74:
    s_barrier
    s_waitcnt lgkmcnt(6)
    v_mfma_f32_16x16x32_bf16 v[64:67], v[212:215], v[0:3], 0
    s_cmp_eq_u32 s38, 1
    s_cbranch_scc1 L_c75
    s_waitcnt vmcnt(5)
    buffer_load_dwordx4 v[168:171], v253, s[12:15], s35 offen offset:3328 nt
L_c75:
    v_mfma_f32_16x16x32_bf16 v[80:83], v[212:215], v[4:7], 0
    ds_read_b64_tr_b16 v[212:213], v250 offset:128
    v_mfma_f32_16x16x32_bf16 v[68:71], v[216:219], v[0:3], 0
    ds_read_b64_tr_b16 v[214:215], v250 offset:6272
    v_mfma_f32_16x16x32_bf16 v[84:87], v[216:219], v[4:7], 0
    ds_read_b64_tr_b16 v[216:217], v251 offset:128
    s_waitcnt lgkmcnt(5)
    v_mfma_f32_16x16x32_bf16 v[72:75], v[220:223], v[0:3], 0
    ds_read_b64_tr_b16 v[218:219], v251 offset:6272
    v_mfma_f32_16x16x32_bf16 v[88:91], v[220:223], v[4:7], 0
    ds_read_b64_tr_b16 v[220:221], v252 offset:128
    v_mfma_f32_16x16x32_bf16 v[76:79], v[224:227], v[0:3], 0
    ds_read_b64_tr_b16 v[222:223], v252 offset:6272
    v_mfma_f32_16x16x32_bf16 v[92:95], v[224:227], v[4:7], 0
    v_mfma_f32_16x16x32_bf16 v[236:239], v[232:235], v[0:3], 0
    ds_read_b64_tr_b16 v[224:225], v249 offset:256
    s_waitcnt lgkmcnt(5)
    v_mfma_f32_16x16x32_bf16 v[96:99], v[228:231], v[0:3], 0
    ds_read_b64_tr_b16 v[226:227], v249 offset:6400
    v_mfma_f32_16x16x32_bf16 v[112:115], v[228:231], v[4:7], 0
    ds_read_b64_tr_b16 v[228:229], v250 offset:256
    v_mfma_f32_16x16x32_bf16 v[100:103], v[212:215], v[0:3], 0
    ds_read_b64_tr_b16 v[230:231], v250 offset:6400
    v_mfma_f32_16x16x32_bf16 v[116:119], v[212:215], v[4:7], 0
    ds_read_b64_tr_b16 v[212:213], v251 offset:256
    s_waitcnt lgkmcnt(5)
    v_mfma_f32_16x16x32_bf16 v[104:107], v[216:219], v[0:3], 0
    ds_read_b64_tr_b16 v[214:215], v251 offset:6400
    v_mfma_f32_16x16x32_bf16 v[120:123], v[216:219], v[4:7], 0
    ds_read_b64_tr_b16 v[216:217], v252 offset:256
    v_mfma_f32_16x16x32_bf16 v[108:111], v[220:223], v[0:3], 0
    ds_read_b64_tr_b16 v[218:219], v252 offset:6400
    s_cmp_eq_u32 s38, 1
    s_cbranch_scc1 L_c76
    s_waitcnt vmcnt(5)
    buffer_load_dwordx4 v[172:175], v253, s[12:15], s42 offen offset:256 nt
L_c76:
    v_mfma_f32_16x16x32_bf16 v[124:127], v[220:223], v[4:7], 0
    ds_read_b64_tr_b16 v[220:221], v249 offset:12288
    s_waitcnt lgkmcnt(5)
    v_mfma_f32_16x16x32_bf16 v[180:183], v[224:227], v[0:3], 0
    ds_read_b64_tr_b16 v[222:223], v249 offset:18432
    v_mfma_f32_16x16x32_bf16 v[196:199], v[224:227], v[4:7], 0
    v_mfma_f32_16x16x32_bf16 v[240:243], v[232:235], v[4:7], 0
    ds_read_b64_tr_b16 v[224:225], v250 offset:12288
    v_mfma_f32_16x16x32_bf16 v[184:187], v[228:231], v[0:3], 0
    ds_read_b64_tr_b16 v[226:227], v250 offset:18432
    v_mfma_f32_16x16x32_bf16 v[200:203], v[228:231], v[4:7], 0
    ds_read_b64_tr_b16 v[228:229], v251 offset:12288
    s_waitcnt lgkmcnt(5)
    v_mfma_f32_16x16x32_bf16 v[188:191], v[212:215], v[0:3], 0
    ds_read_b64_tr_b16 v[230:231], v251 offset:18432
    v_mfma_f32_16x16x32_bf16 v[204:207], v[212:215], v[4:7], 0
    ds_read_b64_tr_b16 v[212:213], v252 offset:12288
    v_mfma_f32_16x16x32_bf16 v[192:195], v[216:219], v[0:3], 0
    ds_read_b64_tr_b16 v[214:215], v252 offset:18432
    v_mfma_f32_16x16x32_bf16 v[208:211], v[216:219], v[4:7], 0
    ds_read_b64_tr_b16 v[216:217], v249 offset:12416
    s_waitcnt lgkmcnt(5)
    v_mfma_f32_16x16x32_bf16 v[64:67], v[220:223], v[8:11], v[64:67]
    ds_read_b64_tr_b16 v[218:219], v249 offset:18560
    v_mfma_f32_16x16x32_bf16 v[80:83], v[220:223], v[12:15], v[80:83]
    ds_read_b64_tr_b16 v[220:221], v250 offset:12416
    v_mfma_f32_16x16x32_bf16 v[68:71], v[224:227], v[8:11], v[68:71]
    ds_read_b64_tr_b16 v[222:223], v250 offset:18560
    v_mfma_f32_16x16x32_bf16 v[84:87], v[224:227], v[12:15], v[84:87]
    ds_read_b64_tr_b16 v[224:225], v251 offset:12416
    s_waitcnt lgkmcnt(5)
    v_mfma_f32_16x16x32_bf16 v[72:75], v[228:231], v[8:11], v[72:75]
    ds_read_b64_tr_b16 v[226:227], v251 offset:18560
    s_cmp_eq_u32 s38, 1
    s_cbranch_scc1 L_c77
    s_waitcnt vmcnt(5)
    buffer_load_dwordx4 v[176:179], v253, s[12:15], s42 offen offset:3328 nt
L_c77:
    v_mfma_f32_16x16x32_bf16 v[88:91], v[228:231], v[12:15], v[88:91]
    ds_read_b64_tr_b16 v[228:229], v252 offset:12416
    v_mfma_f32_16x16x32_bf16 v[76:79], v[212:215], v[8:11], v[76:79]
    ds_read_b64_tr_b16 v[230:231], v252 offset:18560
    v_mfma_f32_16x16x32_bf16 v[92:95], v[212:215], v[12:15], v[92:95]
    v_mfma_f32_16x16x32_bf16 v[236:239], v[232:235], v[8:11], v[236:239]
    ds_read_b64_tr_b16 v[212:213], v249 offset:12544
    s_waitcnt lgkmcnt(5)
    v_mfma_f32_16x16x32_bf16 v[96:99], v[216:219], v[8:11], v[96:99]
    ds_read_b64_tr_b16 v[214:215], v249 offset:18688
    v_mfma_f32_16x16x32_bf16 v[112:115], v[216:219], v[12:15], v[112:115]
    ds_read_b64_tr_b16 v[216:217], v250 offset:12544
    v_mfma_f32_16x16x32_bf16 v[100:103], v[220:223], v[8:11], v[100:103]
    ds_read_b64_tr_b16 v[218:219], v250 offset:18688
    v_add_u32 v249, s28, v249
    v_mfma_f32_16x16x32_bf16 v[116:119], v[220:223], v[12:15], v[116:119]
    ds_read_b64_tr_b16 v[220:221], v251 offset:12544
    s_waitcnt lgkmcnt(5)
    v_mfma_f32_16x16x32_bf16 v[104:107], v[224:227], v[8:11], v[104:107]
    ds_read_b64_tr_b16 v[222:223], v251 offset:18688
    v_add_u32 v250, s28, v250
    v_mfma_f32_16x16x32_bf16 v[120:123], v[224:227], v[12:15], v[120:123]
    ds_read_b64_tr_b16 v[224:225], v252 offset:12544
    v_mfma_f32_16x16x32_bf16 v[108:111], v[228:231], v[8:11], v[108:111]
    ds_read_b64_tr_b16 v[226:227], v252 offset:18688
    v_add_u32 v251, s28, v251
    v_mfma_f32_16x16x32_bf16 v[124:127], v[228:231], v[12:15], v[124:127]
    ds_read_b64_tr_b16 v[228:229], v249 offset:0
    s_waitcnt lgkmcnt(5)
    v_mfma_f32_16x16x32_bf16 v[180:183], v[212:215], v[8:11], v[180:183]
    ds_read_b64_tr_b16 v[230:231], v249 offset:6144
    v_add_u32 v252, s28, v252
    v_mfma_f32_16x16x32_bf16 v[196:199], v[212:215], v[12:15], v[196:199]
    v_mfma_f32_16x16x32_bf16 v[240:243], v[232:235], v[12:15], v[240:243]
    ds_read_b64_tr_b16 v[212:213], v250 offset:0
    v_mfma_f32_16x16x32_bf16 v[184:187], v[216:219], v[8:11], v[184:187]
    ds_read_b64_tr_b16 v[214:215], v250 offset:6144
    s_add_u32 s37, s37, 24576
    v_mfma_f32_16x16x32_bf16 v[200:203], v[216:219], v[12:15], v[200:203]
    ds_read_b64_tr_b16 v[216:217], v251 offset:0
    s_waitcnt lgkmcnt(5)
    v_mfma_f32_16x16x32_bf16 v[188:191], v[220:223], v[8:11], v[188:191]
    ds_read_b64_tr_b16 v[218:219], v251 offset:6144
    s_cmp_eq_u32 s37, 147584
    v_mfma_f32_16x16x32_bf16 v[204:207], v[220:223], v[12:15], v[204:207]
    ds_read_b64_tr_b16 v[220:221], v252 offset:0
    s_cselect_b32 s37, 128, s37
    v_mfma_f32_16x16x32_bf16 v[192:195], v[224:227], v[8:11], v[192:195]
    ds_read_b64_tr_b16 v[222:223], v252 offset:6144
    s_cselect_b32 s28, s29, 24576
    v_mfma_f32_16x16x32_bf16 v[208:211], v[224:227], v[12:15], v[208:211]
    s_cmp_ge_u32 s80, 3
    s_cbranch_scc1 L_tg78
L_tb78:
    s_barrier
    ds_read_b64_tr_b16 v[224:225], v249 offset:128
    s_waitcnt lgkmcnt(5)
    v_mfma_f32_16x16x32_bf16 v[64:67], v[228:231], v[16:19], v[64:67]
    ds_read_b64_tr_b16 v[226:227], v249 offset:6272
    s_cmp_eq_u32 s38, 1
    s_cbranch_scc1 L_c79
    s_sub_u32 m0, s36, 12288
    s_add_u32 s41, s35, 36864
    s_waitcnt vmcnt(5)
    buffer_load_dwordx4 v244, s[16:19], s41 offen nt lds
    s_waitcnt vmcnt(5)
    buffer_load_dwordx4 v245, s[16:19], s41 offen offset:1024 nt lds
    s_waitcnt vmcnt(5)
    buffer_load_dwordx4 v246, s[16:19], s41 offen offset:2048 nt lds
L_c79:
    v_mfma_f32_16x16x32_bf16 v[80:83], v[228:231], v[20:23], v[80:83]
    ds_read_b64_tr_b16 v[228:229], v250 offset:128
    v_mfma_f32_16x16x32_bf16 v[68:71], v[212:215], v[16:19], v[68:71]
    ds_read_b64_tr_b16 v[230:231], v250 offset:6272
    v_mfma_f32_16x16x32_bf16 v[84:87], v[212:215], v[20:23], v[84:87]
    ds_read_b64_tr_b16 v[212:213], v251 offset:128
    s_waitcnt lgkmcnt(5)
    v_mfma_f32_16x16x32_bf16 v[72:75], v[216:219], v[16:19], v[72:75]
    ds_read_b64_tr_b16 v[214:215], v251 offset:6272
    v_mfma_f32_16x16x32_bf16 v[88:91], v[216:219], v[20:23], v[88:91]
    ds_read_b64_tr_b16 v[216:217], v252 offset:128
    v_mfma_f32_16x16x32_bf16 v[76:79], v[220:223], v[16:19], v[76:79]
    ds_read_b64_tr_b16 v[218:219], v252 offset:6272
    v_mfma_f32_16x16x32_bf16 v[92:95], v[220:223], v[20:23], v[92:95]
    v_mfma_f32_16x16x32_bf16 v[236:239], v[232:235], v[16:19], v[236:239]
    ds_read_b64_tr_b16 v[220:221], v249 offset:256
    s_waitcnt lgkmcnt(5)
    v_mfma_f32_16x16x32_bf16 v[96:99], v[224:227], v[16:19], v[96:99]
    ds_read_b64_tr_b16 v[222:223], v249 offset:6400
    v_mfma_f32_16x16x32_bf16 v[112:115], v[224:227], v[20:23], v[112:115]
    ds_read_b64_tr_b16 v[224:225], v250 offset:256
    v_mfma_f32_16x16x32_bf16 v[100:103], v[228:231], v[16:19], v[100:103]
    ds_read_b64_tr_b16 v[226:227], v250 offset:6400
    v_mfma_f32_16x16x32_bf16 v[116:119], v[228:231], v[20:23], v[116:119]
    ds_read_b64_tr_b16 v[228:229], v251 offset:256
    s_waitcnt lgkmcnt(5)
    v_mfma_f32_16x16x32_bf16 v[104:107], v[212:215], v[16:19], v[104:107]
    ds_read_b64_tr_b16 v[230:231], v251 offset:6400
    v_mfma_f32_16x16x32_bf16 v[120:123], v[212:215], v[20:23], v[120:123]
    ds_read_b64_tr_b16 v[212:213], v252 offset:256
    v_mfma_f32_16x16x32_bf16 v[108:111], v[216:219], v[16:19], v[108:111]
    ds_read_b64_tr_b16 v[214:215], v252 offset:6400
    v_mfma_f32_16x16x32_bf16 v[124:127], v[216:219], v[20:23], v[124:127]
    ds_read_b64_tr_b16 v[216:217], v249 offset:12288
    s_waitcnt lgkmcnt(5)
    v_mfma_f32_16x16x32_bf16 v[180:183], v[220:223], v[16:19], v[180:183]
    ds_read_b64_tr_b16 v[218:219], v249 offset:18432
    v_mfma_f32_16x16x32_bf16 v[196:199], v[220:223], v[20:23], v[196:199]
    v_mfma_f32_16x16x32_bf16 v[240:243], v[232:235], v[20:23], v[240:243]
    ds_read_b64_tr_b16 v[220:221], v250 offset:12288
    v_mfma_f32_16x16x32_bf16 v[184:187], v[224:227], v[16:19], v[184:187]
    ds_read_b64_tr_b16 v[222:223], v250 offset:18432
    v_mfma_f32_16x16x32_bf16 v[200:203], v[224:227], v[20:23], v[200:203]
    ds_read_b64_tr_b16 v[224:225], v251 offset:12288
    s_waitcnt lgkmcnt(5)
    v_mfma_f32_16x16x32_bf16 v[188:191], v[228:231], v[16:19], v[188:191]
    ds_read_b64_tr_b16 v[226:227], v251 offset:18432
    v_mfma_f32_16x16x32_bf16 v[204:207], v[228:231], v[20:23], v[204:207]
    ds_read_b64_tr_b16 v[228:229], v252 offset:12288
    v_mfma_f32_16x16x32_bf16 v[192:195], v[212:215], v[16:19], v[192:195]
    ds_read_b64_tr_b16 v[230:231], v252 offset:18432
    v_mfma_f32_16x16x32_bf16 v[208:211], v[212:215], v[20:23], v[208:211]
    ds_read_b64_tr_b16 v[212:213], v249 offset:12416
    s_waitcnt lgkmcnt(5)
    v_mfma_f32_16x16x32_bf16 v[64:67], v[216:219], v[24:27], v[64:67]
    ds_read_b64_tr_b16 v[214:215], v249 offset:18560
    v_mfma_f32_16x16x32_bf16 v[80:83], v[216:219], v[28:31], v[80:83]
    ds_read_b64_tr_b16 v[216:217], v250 offset:12416
    v_mfma_f32_16x16x32_bf16 v[68:71], v[220:223], v[24:27], v[68:71]
    ds_read_b64_tr_b16 v[218:219], v250 offset:18560
    v_mfma_f32_16x16x32_bf16 v[84:87], v[220:223], v[28:31], v[84:87]
    ds_read_b64_tr_b16 v[220:221], v251 offset:12416
    s_waitcnt lgkmcnt(5)
    v_mfma_f32_16x16x32_bf16 v[72:75], v[224:227], v[24:27], v[72:75]
    ds_read_b64_tr_b16 v[222:223], v251 offset:18560
    v_mfma_f32_16x16x32_bf16 v[88:91], v[224:227], v[28:31], v[88:91]
    ds_read_b64_tr_b16 v[224:225], v252 offset:12416
    v_mfma_f32_16x16x32_bf16 v[76:79], v[228:231], v[24:27], v[76:79]
    ds_read_b64_tr_b16 v[226:227], v252 offset:18560
    v_mfma_f32_16x16x32_bf16 v[92:95], v[228:231], v[28:31], v[92:95]
    v_mfma_f32_16x16x32_bf16 v[236:239], v[232:235], v[24:27], v[236:239]
    ds_read_b64_tr_b16 v[228:229], v249 offset:12544
    s_waitcnt lgkmcnt(5)
    v_mfma_f32_16x16x32_bf16 v[96:99], v[212:215], v[24:27], v[96:99]
    ds_read_b64_tr_b16 v[230:231], v249 offset:18688
    v_mfma_f32_16x16x32_bf16 v[112:115], v[212:215], v[28:31], v[112:115]
    ds_read_b64_tr_b16 v[212:213], v250 offset:12544
    v_mfma_f32_16x16x32_bf16 v[100:103], v[216:219], v[24:27], v[100:103]
    ds_read_b64_tr_b16 v[214:215], v250 offset:18688
    v_add_u32 v249, s28, v249
    v_mfma_f32_16x16x32_bf16 v[116:119], v[216:219], v[28:31], v[116:119]
    ds_read_b64_tr_b16 v[216:217], v251 offset:12544
    s_waitcnt lgkmcnt(5)
    v_mfma_f32_16x16x32_bf16 v[104:107], v[220:223], v[24:27], v[104:107]
    ds_read_b64_tr_b16 v[218:219], v251 offset:18688
    v_add_u32 v250, s28, v250
    v_mfma_f32_16x16x32_bf16 v[120:123], v[220:223], v[28:31], v[120:123]
    ds_read_b64_tr_b16 v[220:221], v252 offset:12544
    v_mfma_f32_16x16x32_bf16 v[108:111], v[224:227], v[24:27], v[108:111]
    ds_read_b64_tr_b16 v[222:223], v252 offset:18688
    v_add_u32 v251, s28, v251
    v_mfma_f32_16x16x32_bf16 v[124:127], v[224:227], v[28:31], v[124:127]
    ds_read_b64_tr_b16 v[224:225], v249 offset:0
    s_waitcnt lgkmcnt(5)
    v_mfma_f32_16x16x32_bf16 v[180:183], v[228:231], v[24:27], v[180:183]
    ds_read_b64_tr_b16 v[226:227], v249 offset:6144
    v_add_u32 v252, s28, v252
    v_mfma_f32_16x16x32_bf16 v[196:199], v[228:231], v[28:31], v[196:199]
    v_mfma_f32_16x16x32_bf16 v[240:243], v[232:235], v[28:31], v[240:243]
    ds_read_b64_tr_b16 v[228:229], v250 offset:0
    v_mfma_f32_16x16x32_bf16 v[184:187], v[212:215], v[24:27], v[184:187]
    ds_read_b64_tr_b16 v[230:231], v250 offset:6144
    s_add_u32 s37, s37, 24576
    v_mfma_f32_16x16x32_bf16 v[200:203], v[212:215], v[28:31], v[200:203]
    ds_read_b64_tr_b16 v[212:213], v251 offset:0
    s_waitcnt lgkmcnt(5)
    v_mfma_f32_16x16x32_bf16 v[188:191], v[216:219], v[24:27], v[188:191]
    ds_read_b64_tr_b16 v[214:215], v251 offset:6144
    s_cmp_eq_u32 s37, 147584
    v_mfma_f32_16x16x32_bf16 v[204:207], v[216:219], v[28:31], v[204:207]
    ds_read_b64_tr_b16 v[216:217], v252 offset:0
    s_cselect_b32 s37, 128, s37
    v_mfma_f32_16x16x32_bf16 v[192:195], v[220:223], v[24:27], v[192:195]
    ds_read_b64_tr_b16 v[218:219], v252 offset:6144
    s_cselect_b32 s28, s29, 24576
    v_mfma_f32_16x16x32_bf16 v[208:211], v[220:223], v[28:31], v[208:211]
    s_cmp_ge_u32 s80, 2
    s_cbranch_scc1 L_tg80
L_tb80:
    s_barrier
    ds_read_b64_tr_b16 v[220:221], v249 offset:128
    s_waitcnt lgkmcnt(5)
    v_mfma_f32_16x16x32_bf16 v[64:67], v[224:227], v[32:35], v[64:67]
    ds_read_b64_tr_b16 v[222:223], v249 offset:6272
    s_cmp_eq_u32 s38, 1
    s_cbranch_scc1 L_c81
    s_mov_b32 m0, s36
    s_add_u32 s41, s35, 49152
    s_waitcnt vmcnt(5)
    buffer_load_dwordx4 v244, s[16:19], s41 offen nt lds
    s_waitcnt vmcnt(5)
    buffer_load_dwordx4 v245, s[16:19], s41 offen offset:1024 nt lds
    s_waitcnt vmcnt(5)
    buffer_load_dwordx4 v246, s[16:19], s41 offen offset:2048 nt lds
    s_add_u32 s36, s36, 24576
    s_cmp_eq_u32 s36, s45
    s_cselect_b32 s36, s33, s36
L_c81:
    v_mfma_f32_16x16x32_bf16 v[80:83], v[224:227], v[36:39], v[80:83]
    ds_read_b64_tr_b16 v[224:225], v250 offset:128
    v_mfma_f32_16x16x32_bf16 v[68:71], v[228:231], v[32:35], v[68:71]
    ds_read_b64_tr_b16 v[226:227], v250 offset:6272
    v_mfma_f32_16x16x32_bf16 v[84:87], v[228:231], v[36:39], v[84:87]
    ds_read_b64_tr_b16 v[228:229], v251 offset:128
    s_waitcnt lgkmcnt(5)
    v_mfma_f32_16x16x32_bf16 v[72:75], v[212:215], v[32:35], v[72:75]
    ds_read_b64_tr_b16 v[230:231], v251 offset:6272
    v_mfma_f32_16x16x32_bf16 v[88:91], v[212:215], v[36:39], v[88:91]
    ds_read_b64_tr_b16 v[212:213], v252 offset:128
    v_mfma_f32_16x16x32_bf16 v[76:79], v[216:219], v[32:35], v[76:79]
    ds_read_b64_tr_b16 v[214:215], v252 offset:6272
    v_mfma_f32_16x16x32_bf16 v[92:95], v[216:219], v[36:39], v[92:95]
    v_mfma_f32_16x16x32_bf16 v[236:239], v[232:235], v[32:35], v[236:239]
    ds_read_b64_tr_b16 v[216:217], v249 offset:256
    s_waitcnt lgkmcnt(5)
    v_mfma_f32_16x16x32_bf16 v[96:99], v[220:223], v[32:35], v[96:99]
    ds_read_b64_tr_b16 v[218:219], v249 offset:6400
    v_mfma_f32_16x16x32_bf16 v[112:115], v[220:223], v[36:39], v[112:115]
    ds_read_b64_tr_b16 v[220:221], v250 offset:256
    v_mfma_f32_16x16x32_bf16 v[100:103], v[224:227], v[32:35], v[100:103]
    ds_read_b64_tr_b16 v[222:223], v250 offset:6400
    v_mfma_f32_16x16x32_bf16 v[116:119], v[224:227], v[36:39], v[116:119]
    ds_read_b64_tr_b16 v[224:225], v251 offset:256
    s_waitcnt lgkmcnt(5)
    v_mfma_f32_16x16x32_bf16 v[104:107], v[228:231], v[32:35], v[104:107]
    ds_read_b64_tr_b16 v[226:227], v251 offset:6400
    v_mfma_f32_16x16x32_bf16 v[120:123], v[228:231], v[36:39], v[120:123]
    ds_read_b64_tr_b16 v[228:229], v252 offset:256
    v_mfma_f32_16x16x32_bf16 v[108:111], v[212:215], v[32:35], v[108:111]
    ds_read_b64_tr_b16 v[230:231], v252 offset:6400
    v_mfma_f32_16x16x32_bf16 v[124:127], v[212:215], v[36:39], v[124:127]
    ds_read_b64_tr_b16 v[212:213], v249 offset:12288
    s_waitcnt lgkmcnt(5)
    v_mfma_f32_16x16x32_bf16 v[180:183], v[216:219], v[32:35], v[180:183]
    ds_read_b64_tr_b16 v[214:215], v249 offset:18432
    v_mfma_f32_16x16x32_bf16 v[196:199], v[216:219], v[36:39], v[196:199]
    v_mfma_f32_16x16x32_bf16 v[240:243], v[232:235], v[36:39], v[240:243]
    ds_read_b64_tr_b16 v[216:217], v250 offset:12288
    v_mfma_f32_16x16x32_bf16 v[184:187], v[220:223], v[32:35], v[184:187]
    ds_read_b64_tr_b16 v[218:219], v250 offset:18432
    v_mfma_f32_16x16x32_bf16 v[200:203], v[220:223], v[36:39], v[200:203]
    ds_read_b64_tr_b16 v[220:221], v251 offset:12288
    s_waitcnt lgkmcnt(5)
    v_mfma_f32_16x16x32_bf16 v[188:191], v[224:227], v[32:35], v[188:191]
    ds_read_b64_tr_b16 v[222:223], v251 offset:18432
    v_mfma_f32_16x16x32_bf16 v[204:207], v[224:227], v[36:39], v[204:207]
    ds_read_b64_tr_b16 v[224:225], v252 offset:12288
    v_mfma_f32_16x16x32_bf16 v[192:195], v[228:231], v[32:35], v[192:195]
    ds_read_b64_tr_b16 v[226:227], v252 offset:18432
    v_mfma_f32_16x16x32_bf16 v[208:211], v[228:231], v[36:39], v[208:211]
    ds_read_b64_tr_b16 v[228:229], v249 offset:12416
    s_waitcnt lgkmcnt(5)
    v_mfma_f32_16x16x32_bf16 v[64:67], v[212:215], v[40:43], v[64:67]
    ds_read_b64_tr_b16 v[230:231], v249 offset:18560
    v_mfma_f32_16x16x32_bf16 v[80:83], v[212:215], v[44:47], v[80:83]
    ds_read_b64_tr_b16 v[212:213], v250 offset:12416
    v_mfma_f32_16x16x32_bf16 v[68:71], v[216:219], v[40:43], v[68:71]
    ds_read_b64_tr_b16 v[214:215], v250 offset:18560
    v_mfma_f32_16x16x32_bf16 v[84:87], v[216:219], v[44:47], v[84:87]
    ds_read_b64_tr_b16 v[216:217], v251 offset:12416
    s_waitcnt lgkmcnt(5)
    v_mfma_f32_16x16x32_bf16 v[72:75], v[220:223], v[40:43], v[72:75]
    ds_read_b64_tr_b16 v[218:219], v251 offset:18560
    v_mfma_f32_16x16x32_bf16 v[88:91], v[220:223], v[44:47], v[88:91]
    ds_read_b64_tr_b16 v[220:221], v252 offset:12416
    v_mfma_f32_16x16x32_bf16 v[76:79], v[224:227], v[40:43], v[76:79]
    ds_read_b64_tr_b16 v[222:223], v252 offset:18560
    v_mfma_f32_16x16x32_bf16 v[92:95], v[224:227], v[44:47], v[92:95]
    v_mfma_f32_16x16x32_bf16 v[236:239], v[232:235], v[40:43], v[236:239]
    ds_read_b64_tr_b16 v[224:225], v249 offset:12544
    s_waitcnt lgkmcnt(5)
    v_mfma_f32_16x16x32_bf16 v[96:99], v[228:231], v[40:43], v[96:99]
    ds_read_b64_tr_b16 v[226:227], v249 offset:18688
    v_mfma_f32_16x16x32_bf16 v[112:115], v[228:231], v[44:47], v[112:115]
    ds_read_b64_tr_b16 v[228:229], v250 offset:12544
    v_mfma_f32_16x16x32_bf16 v[100:103], v[212:215], v[40:43], v[100:103]
    ds_read_b64_tr_b16 v[230:231], v250 offset:18688
    v_add_u32 v249, s28, v249
    v_mfma_f32_16x16x32_bf16 v[116:119], v[212:215], v[44:47], v[116:119]
    ds_read_b64_tr_b16 v[212:213], v251 offset:12544
    s_waitcnt lgkmcnt(5)
    v_mfma_f32_16x16x32_bf16 v[104:107], v[216:219], v[40:43], v[104:107]
    ds_read_b64_tr_b16 v[214:215], v251 offset:18688
    v_add_u32 v250, s28, v250
    v_mfma_f32_16x16x32_bf16 v[120:123], v[216:219], v[44:47], v[120:123]
    ds_read_b64_tr_b16 v[216:217], v252 offset:12544
    v_mfma_f32_16x16x32_bf16 v[108:111], v[220:223], v[40:43], v[108:111]
    ds_read_b64_tr_b16 v[218:219], v252 offset:18688
    v_add_u32 v251, s28, v251
    v_mfma_f32_16x16x32_bf16 v[124:127], v[220:223], v[44:47], v[124:127]
    ds_read_b64_tr_b16 v[220:221], v249 offset:0
    s_waitcnt lgkmcnt(5)
    v_mfma_f32_16x16x32_bf16 v[180:183], v[224:227], v[40:43], v[180:183]
    ds_read_b64_tr_b16 v[222:223], v249 offset:6144
    v_add_u32 v252, s28, v252
    v_mfma_f32_16x16x32_bf16 v[196:199], v[224:227], v[44:47], v[196:199]
    v_mfma_f32_16x16x32_bf16 v[240:243], v[232:235], v[44:47], v[240:243]
    ds_read_b64_tr_b16 v[224:225], v250 offset:0
    v_mfma_f32_16x16x32_bf16 v[184:187], v[228:231], v[40:43], v[184:187]
    ds_read_b64_tr_b16 v[226:227], v250 offset:6144
    s_add_u32 s37, s37, 24576
    v_mfma_f32_16x16x32_bf16 v[200:203], v[228:231], v[44:47], v[200:203]
    ds_read_b64_tr_b16 v[228:229], v251 offset:0
    s_waitcnt lgkmcnt(5)
    v_mfma_f32_16x16x32_bf16 v[188:191], v[212:215], v[40:43], v[188:191]
    ds_read_b64_tr_b16 v[230:231], v251 offset:6144
    s_cmp_eq_u32 s37, 147584
    v_mfma_f32_16x16x32_bf16 v[204:207], v[212:215], v[44:47], v[204:207]
    ds_read_b64_tr_b16 v[212:213], v252 offset:0
    s_cselect_b32 s37, 128, s37
    v_mfma_f32_16x16x32_bf16 v[192:195], v[216:219], v[40:43], v[192:195]
    ds_read_b64_tr_b16 v[214:215], v252 offset:6144
    s_cselect_b32 s28, s29, 24576
    v_mfma_f32_16x16x32_bf16 v[208:211], v[216:219], v[44:47], v[208:211]
    s_cmp_ge_u32 s80, 3
    s_cbranch_scc1 L_tg82
L_tb82:
    s_barrier
    ds_read_b64_tr_b16 v[216:217], v249 offset:128
    s_waitcnt lgkmcnt(5)
    v_mfma_f32_16x16x32_bf16 v[64:67], v[220:223], v[48:51], v[64:67]
    ds_read_b64_tr_b16 v[218:219], v249 offset:6272
    ds_read_b32 v254, v247
    v_mfma_f32_16x16x32_bf16 v[80:83], v[220:223], v[52:55], v[80:83]
    ds_read_b64_tr_b16 v[220:221], v250 offset:128
    v_mfma_f32_16x16x32_bf16 v[68:71], v[224:227], v[48:51], v[68:71]
    ds_read_b64_tr_b16 v[222:223], v250 offset:6272
    v_mfma_f32_16x16x32_bf16 v[84:87], v[224:227], v[52:55], v[84:87]
    ds_read_b64_tr_b16 v[224:225], v251 offset:128
    s_waitcnt lgkmcnt(6)
    v_mfma_f32_16x16x32_bf16 v[72:75], v[228:231], v[48:51], v[72:75]
    ds_read_b64_tr_b16 v[226:227], v251 offset:6272
    v_mfma_f32_16x16x32_bf16 v[88:91], v[228:231], v[52:55], v[88:91]
    ds_read_b64_tr_b16 v[228:229], v252 offset:128
    v_mfma_f32_16x16x32_bf16 v[76:79], v[212:215], v[48:51], v[76:79]
    ds_read_b64_tr_b16 v[230:231], v252 offset:6272
    v_mfma_f32_16x16x32_bf16 v[92:95], v[212:215], v[52:55], v[92:95]
    v_mfma_f32_16x16x32_bf16 v[236:239], v[232:235], v[48:51], v[236:239]
    ds_read_b64_tr_b16 v[212:213], v249 offset:256
    s_waitcnt lgkmcnt(5)
    v_mfma_f32_16x16x32_bf16 v[96:99], v[216:219], v[48:51], v[96:99]
    ds_read_b64_tr_b16 v[214:215], v249 offset:6400
    v_mfma_f32_16x16x32_bf16 v[112:115], v[216:219], v[52:55], v[112:115]
    ds_read_b64_tr_b16 v[216:217], v250 offset:256
    v_mfma_f32_16x16x32_bf16 v[100:103], v[220:223], v[48:51], v[100:103]
    ds_read_b64_tr_b16 v[218:219], v250 offset:6400
    v_mfma_f32_16x16x32_bf16 v[116:119], v[220:223], v[52:55], v[116:119]
    ds_read_b64_tr_b16 v[220:221], v251 offset:256
    s_waitcnt lgkmcnt(5)
    v_mfma_f32_16x16x32_bf16 v[104:107], v[224:227], v[48:51], v[104:107]
    ds_read_b64_tr_b16 v[222:223], v251 offset:6400
    v_mfma_f32_16x16x32_bf16 v[120:123], v[224:227], v[52:55], v[120:123]
    ds_read_b64_tr_b16 v[224:225], v252 offset:256
    v_mfma_f32_16x16x32_bf16 v[108:111], v[228:231], v[48:51], v[108:111]
    ds_read_b64_tr_b16 v[226:227], v252 offset:6400
    s_cmp_eq_u32 s38, 1
    s_cbranch_scc1 L_c83
    s_sub_u32 m0, s36, 12288
    s_add_u32 s41, s35, 61440
    s_waitcnt vmcnt(5)
    buffer_load_dwordx4 v244, s[16:19], s41 offen nt lds
    s_waitcnt vmcnt(5)
    buffer_load_dwordx4 v245, s[16:19], s41 offen offset:1024 nt lds
    s_waitcnt vmcnt(5)
    buffer_load_dwordx4 v246, s[16:19], s41 offen offset:2048 nt lds
L_c83:
    v_mfma_f32_16x16x32_bf16 v[124:127], v[228:231], v[52:55], v[124:127]
    ds_read_b64_tr_b16 v[228:229], v249 offset:12288
    s_waitcnt lgkmcnt(5)
    v_mfma_f32_16x16x32_bf16 v[180:183], v[212:215], v[48:51], v[180:183]
    ds_read_b64_tr_b16 v[230:231], v249 offset:18432
    v_mfma_f32_16x16x32_bf16 v[196:199], v[212:215], v[52:55], v[196:199]
    v_mfma_f32_16x16x32_bf16 v[240:243], v[232:235], v[52:55], v[240:243]
    ds_read_b64_tr_b16 v[212:213], v250 offset:12288
    v_mfma_f32_16x16x32_bf16 v[184:187], v[216:219], v[48:51], v[184:187]
    ds_read_b64_tr_b16 v[214:215], v250 offset:18432
    v_mfma_f32_16x16x32_bf16 v[200:203], v[216:219], v[52:55], v[200:203]
    ds_read_b64_tr_b16 v[216:217], v251 offset:12288
    s_waitcnt lgkmcnt(5)
    v_mfma_f32_16x16x32_bf16 v[188:191], v[220:223], v[48:51], v[188:191]
    ds_read_b64_tr_b16 v[218:219], v251 offset:18432
    v_mfma_f32_16x16x32_bf16 v[204:207], v[220:223], v[52:55], v[204:207]
    ds_read_b64_tr_b16 v[220:221], v252 offset:12288
    v_mfma_f32_16x16x32_bf16 v[192:195], v[224:227], v[48:51], v[192:195]
    ds_read_b64_tr_b16 v[222:223], v252 offset:18432
    v_mfma_f32_16x16x32_bf16 v[208:211], v[224:227], v[52:55], v[208:211]
    ds_read_b64_tr_b16 v[224:225], v249 offset:12416
    s_waitcnt lgkmcnt(5)
    v_mfma_f32_16x16x32_bf16 v[64:67], v[228:231], v[56:59], v[64:67]
    ds_read_b64_tr_b16 v[226:227], v249 offset:18560
    v_mfma_f32_16x16x32_bf16 v[80:83], v[228:231], v[60:63], v[80:83]
    ds_read_b64_tr_b16 v[228:229], v250 offset:12416
    v_mfma_f32_16x16x32_bf16 v[68:71], v[212:215], v[56:59], v[68:71]
    ds_read_b64_tr_b16 v[230:231], v250 offset:18560
    v_mfma_f32_16x16x32_bf16 v[84:87], v[212:215], v[60:63], v[84:87]
    ds_read_b64_tr_b16 v[212:213], v251 offset:12416
    s_waitcnt lgkmcnt(5)
    v_mfma_f32_16x16x32_bf16 v[72:75], v[216:219], v[56:59], v[72:75]
    ds_read_b64_tr_b16 v[214:215], v251 offset:18560
    v_mfma_f32_16x16x32_bf16 v[88:91], v[216:219], v[60:63], v[88:91]
    ds_read_b64_tr_b16 v[216:217], v252 offset:12416
    v_readfirstlane_b32 s81, v254
    v_mfma_f32_16x16x32_bf16 v[76:79], v[220:223], v[56:59], v[76:79]
    ds_read_b64_tr_b16 v[218:219], v252 offset:18560
    s_cmp_lt_i32 s81, 10
    v_mfma_f32_16x16x32_bf16 v[92:95], v[220:223], v[60:63], v[92:95]
    s_cselect_b32 s80, 1, 0
    s_cmp_lt_i32 s81, 6
    v_mfma_f32_16x16x32_bf16 v[236:239], v[232:235], v[56:59], v[236:239]
    ds_read_b64_tr_b16 v[220:221], v249 offset:12544
    s_waitcnt lgkmcnt(5)
    v_mfma_f32_16x16x32_bf16 v[96:99], v[224:227], v[56:59], v[96:99]
    ds_read_b64_tr_b16 v[222:223], v249 offset:18688
    s_cselect_b32 s80, 2, s80
    v_mfma_f32_16x16x32_bf16 v[112:115], v[224:227], v[60:63], v[112:115]
    ds_read_b64_tr_b16 v[224:225], v250 offset:12544
    s_cmp_lt_i32 s81, 3
    v_mfma_f32_16x16x32_bf16 v[100:103], v[228:231], v[56:59], v[100:103]
    ds_read_b64_tr_b16 v[226:227], v250 offset:18688
    s_cselect_b32 s80, 3, s80
    v_mfma_f32_16x16x32_bf16 v[116:119], v[228:231], v[60:63], v[116:119]
    ds_read_b64_tr_b16 v[228:229], v251 offset:12544
    s_waitcnt lgkmcnt(5)
    v_mfma_f32_16x16x32_bf16 v[104:107], v[212:215], v[56:59], v[104:107]
    ds_read_b64_tr_b16 v[230:231], v251 offset:18688
    s_cmp_eq_u32 s38, 1
    v_mfma_f32_16x16x32_bf16 v[120:123], v[212:215], v[60:63], v[120:123]
    ds_read_b64_tr_b16 v[212:213], v252 offset:12544
    s_cselect_b32 s80, 0, s80
    v_mfma_f32_16x16x32_bf16 v[108:111], v[216:219], v[56:59], v[108:111]
    ds_read_b64_tr_b16 v[214:215], v252 offset:18688
    s_cmp_le_u32 s38, 2
    v_mfma_f32_16x16x32_bf16 v[124:127], v[216:219], v[60:63], v[124:127]
    s_cselect_b32 s81, 2, 9
    s_waitcnt lgkmcnt(4)
    v_mfma_f32_16x16x32_bf16 v[180:183], v[220:223], v[56:59], v[180:183]
    s_min_u32 s80, s80, s81
    s_cmp_le_u32 s38, 1
    v_mfma_f32_16x16x32_bf16 v[196:199], v[220:223], v[60:63], v[196:199]
    s_cselect_b32 s81, 1, 9
    s_min_u32 s80, s80, s81
    v_mfma_f32_16x16x32_bf16 v[240:243], v[232:235], v[60:63], v[240:243]
    v_mfma_f32_16x16x32_bf16 v[184:187], v[224:227], v[56:59], v[184:187]
    v_mfma_f32_16x16x32_bf16 v[200:203], v[224:227], v[60:63], v[200:203]
    s_waitcnt lgkmcnt(0)
    v_mfma_f32_16x16x32_bf16 v[188:191], v[228:231], v[56:59], v[188:191]
    v_mfma_f32_16x16x32_bf16 v[204:207], v[228:231], v[60:63], v[204:207]
    v_mfma_f32_16x16x32_bf16 v[192:195], v[212:215], v[56:59], v[192:195]
    v_mfma_f32_16x16x32_bf16 v[208:211], v[212:215], v[60:63], v[208:211]
    s_cmp_ge_u32 s80, 1
    s_cbranch_scc1 L_tg84
L_tb84:
    s_barrier
    s_mov_b32 s43, s34
    s_add_u32 s44, s34, 6144
    s_mov_b32 s26, 100663296
    s_nop 3
    s_nop 3
    v_rcp_f32 v236, v236
    v_rcp_f32 v240, v240
    s_cmp_eq_u32 s38, 1
    s_cbranch_scc1 L_c85
    s_mov_b32 m0, s36
    s_add_u32 s41, s35, 73728
    s_waitcnt vmcnt(5)
    buffer_load_dwordx4 v244, s[16:19], s41 offen nt lds
    s_waitcnt vmcnt(5)
    buffer_load_dwordx4 v245, s[16:19], s41 offen offset:1024 nt lds
    s_waitcnt vmcnt(5)
    buffer_load_dwordx4 v246, s[16:19], s41 offen offset:2048 nt lds
    s_add_u32 s36, s36, 73728
    s_cmp_ge_u32 s36, s45
    s_cselect_b32 s41, 147456, 0
    s_sub_u32 s36, s36, s41
L_c85:
    v_mul_f32 v64, v64, v236
    v_mul_f32 v65, v65, v236
    v_mul_f32 v66, v66, v236
    v_mul_f32 v67, v67, v236
    v_mul_f32 v68, v68, v236
    v_mul_f32 v69, v69, v236
    v_mul_f32 v70, v70, v236
    v_mul_f32 v71, v71, v236
    v_cvt_pk_bf16_f32 v64, v64, v65
    v_cvt_pk_bf16_f32 v65, v66, v67
    v_cvt_pk_bf16_f32 v66, v68, v69
    v_cvt_pk_bf16_f32 v67, v70, v71
    v_mul_f32 v72, v72, v236
    v_mul_f32 v73, v73, v236
    v_mul_f32 v74, v74, v236
    v_mul_f32 v75, v75, v236
    v_mul_f32 v76, v76, v236
    v_mul_f32 v77, v77, v236
    v_mul_f32 v78, v78, v236
    v_mul_f32 v79, v79, v236
    v_cvt_pk_bf16_f32 v68, v72, v73
    v_cvt_pk_bf16_f32 v69, v74, v75
    v_cvt_pk_bf16_f32 v70, v76, v77
    v_cvt_pk_bf16_f32 v71, v78, v79
    v_mul_f32 v80, v80, v240
    v_mul_f32 v81, v81, v240
    v_mul_f32 v82, v82, v240
    v_mul_f32 v83, v83, v240
    v_mul_f32 v84, v84, v240
    v_mul_f32 v85, v85, v240
    v_mul_f32 v86, v86, v240
    v_mul_f32 v87, v87, v240
    v_cvt_pk_bf16_f32 v72, v80, v81
    v_cvt_pk_bf16_f32 v73, v82, v83
    v_cvt_pk_bf16_f32 v74, v84, v85
    v_cvt_pk_bf16_f32 v75, v86, v87
    v_mul_f32 v88, v88, v240
    v_mul_f32 v89, v89, v240
    v_mul_f32 v90, v90, v240
    v_mul_f32 v91, v91, v240
    v_mul_f32 v92, v92, v240
    v_mul_f32 v93, v93, v240
    v_mul_f32 v94, v94, v240
    v_mul_f32 v95, v95, v240
    v_cvt_pk_bf16_f32 v76, v88, v89
    v_cvt_pk_bf16_f32 v77, v90, v91
    v_cvt_pk_bf16_f32 v78, v92, v93
    v_cvt_pk_bf16_f32 v79, v94, v95
    v_cndmask_b32_dpp v80, v68, v64, vcc row_ror:8 row_mask:0xf bank_mask:0xf
    v_cndmask_b32_dpp v81, v69, v65, vcc row_ror:8 row_mask:0xf bank_mask:0xf
    v_cndmask_b32_dpp v82, v70, v66, vcc row_ror:8 row_mask:0xf bank_mask:0xf
    v_cndmask_b32_dpp v83, v71, v67, vcc row_ror:8 row_mask:0xf bank_mask:0xf
    v_mov_b32_dpp v68, v64 row_ror:8 row_mask:0xf bank_mask:0x3
    v_mov_b32_dpp v69, v65 row_ror:8 row_mask:0xf bank_mask:0x3
    v_mov_b32_dpp v70, v66 row_ror:8 row_mask:0xf bank_mask:0x3
    v_mov_b32_dpp v71, v67 row_ror:8 row_mask:0xf bank_mask:0x3
    v_cndmask_b32_dpp v64, v76, v72, vcc row_ror:8 row_mask:0xf bank_mask:0xf
    v_cndmask_b32_dpp v65, v77, v73, vcc row_ror:8 row_mask:0xf bank_mask:0xf
    v_cndmask_b32_dpp v66, v78, v74, vcc row_ror:8 row_mask:0xf bank_mask:0xf
    v_cndmask_b32_dpp v67, v79, v75, vcc row_ror:8 row_mask:0xf bank_mask:0xf
    v_mov_b32_dpp v76, v72 row_ror:8 row_mask:0xf bank_mask:0x3
    v_mov_b32_dpp v77, v73 row_ror:8 row_mask:0xf bank_mask:0x3
    v_mov_b32_dpp v78, v74 row_ror:8 row_mask:0xf bank_mask:0x3
    v_mov_b32_dpp v79, v75 row_ror:8 row_mask:0xf bank_mask:0x3
    v_permlane16_swap_b32 v80, v82
    v_permlane16_swap_b32 v81, v83
    v_permlane16_swap_b32 v68, v70
    v_permlane16_swap_b32 v69, v71
    s_cmp_ge_u32 s80, 3
    s_cbranch_scc1 L_tg86
L_tb86:
    s_cmp_eq_u32 s38, 1
    s_cbranch_scc1 L_nb87
    s_barrier
L_nb87:
    v_permlane16_swap_b32 v64, v66
    v_permlane16_swap_b32 v65, v67
    v_permlane16_swap_b32 v76, v78
    v_permlane16_swap_b32 v77, v79
    v_mul_f32 v96, v96, v236
    s_waitcnt vmcnt(5)
    buffer_store_dwordx4 v[80:83], v253, s[24:27], s43 offen sc1
    v_mul_f32 v97, v97, v236
    v_mul_f32 v98, v98, v236
    v_mul_f32 v99, v99, v236
    v_mul_f32 v100, v100, v236
    v_mul_f32 v101, v101, v236
    v_mul_f32 v102, v102, v236
    v_mul_f32 v103, v103, v236
    v_cvt_pk_bf16_f32 v96, v96, v97
    v_cvt_pk_bf16_f32 v97, v98, v99
    v_cvt_pk_bf16_f32 v98, v100, v101
    v_cvt_pk_bf16_f32 v99, v102, v103
    v_mul_f32 v104, v104, v236
    v_mul_f32 v105, v105, v236
    v_mul_f32 v106, v106, v236
    v_mul_f32 v107, v107, v236
    v_mul_f32 v108, v108, v236
    v_mul_f32 v109, v109, v236
    s_cmp_eq_u32 s38, 2
    s_cbranch_scc1 L_c88
    s_waitcnt vmcnt(5)
    buffer_store_dwordx4 v[68:71], v253, s[24:27], s43 offen offset:3072 sc1
L_c88:
    v_mul_f32 v110, v110, v236
    v_mul_f32 v111, v111, v236
    v_cvt_pk_bf16_f32 v100, v104, v105
    v_cvt_pk_bf16_f32 v101, v106, v107
    v_cvt_pk_bf16_f32 v102, v108, v109
    v_cvt_pk_bf16_f32 v103, v110, v111
    v_mul_f32 v112, v112, v240
    v_mul_f32 v113, v113, v240
    v_mul_f32 v114, v114, v240
    v_mul_f32 v115, v115, v240
    v_mul_f32 v116, v116, v240
    v_mul_f32 v117, v117, v240
    v_mul_f32 v118, v118, v240
    v_mul_f32 v119, v119, v240
    v_cvt_pk_bf16_f32 v104, v112, v113
    v_cvt_pk_bf16_f32 v105, v114, v115
    v_cvt_pk_bf16_f32 v106, v116, v117
    v_cvt_pk_bf16_f32 v107, v118, v119
    v_mul_f32 v120, v120, v240
    v_mul_f32 v121, v121, v240
    v_mul_f32 v122, v122, v240
    v_mul_f32 v123, v123, v240
    v_mul_f32 v124, v124, v240
    s_cmp_eq_u32 s38, 2
    s_cbranch_scc1 L_c89
    s_waitcnt vmcnt(5)
    buffer_store_dwordx4 v[64:67], v253, s[24:27], s44 offen sc1
L_c89:
    v_mul_f32 v125, v125, v240
    v_mul_f32 v126, v126, v240
    v_mul_f32 v127, v127, v240
    v_cvt_pk_bf16_f32 v108, v120, v121
    v_cvt_pk_bf16_f32 v109, v122, v123
    v_cvt_pk_bf16_f32 v110, v124, v125
    v_cvt_pk_bf16_f32 v111, v126, v127
    v_cndmask_b32_dpp v112, v100, v96, vcc row_ror:8 row_mask:0xf bank_mask:0xf
    v_cndmask_b32_dpp v113, v101, v97, vcc row_ror:8 row_mask:0xf bank_mask:0xf
    v_cndmask_b32_dpp v114, v102, v98, vcc row_ror:8 row_mask:0xf bank_mask:0xf
    v_cndmask_b32_dpp v115, v103, v99, vcc row_ror:8 row_mask:0xf bank_mask:0xf
    v_mov_b32_dpp v100, v96 row_ror:8 row_mask:0xf bank_mask:0x3
    v_mov_b32_dpp v101, v97 row_ror:8 row_mask:0xf bank_mask:0x3
    v_mov_b32_dpp v102, v98 row_ror:8 row_mask:0xf bank_mask:0x3
    v_mov_b32_dpp v103, v99 row_ror:8 row_mask:0xf bank_mask:0x3
    v_cndmask_b32_dpp v96, v108, v104, vcc row_ror:8 row_mask:0xf bank_mask:0xf
    v_cndmask_b32_dpp v97, v109, v105, vcc row_ror:8 row_mask:0xf bank_mask:0xf
    v_cndmask_b32_dpp v98, v110, v106, vcc row_ror:8 row_mask:0xf bank_mask:0xf
    v_cndmask_b32_dpp v99, v111, v107, vcc row_ror:8 row_mask:0xf bank_mask:0xf
    v_mov_b32_dpp v108, v104 row_ror:8 row_mask:0xf bank_mask:0x3
    v_mov_b32_dpp v109, v105 row_ror:8 row_mask:0xf bank_mask:0x3
    v_mov_b32_dpp v110, v106 row_ror:8 row_mask:0xf bank_mask:0x3
    v_mov_b32_dpp v111, v107 row_ror:8 row_mask:0xf bank_mask:0x3
    s_cmp_ge_u32 s80, 2
    s_cbranch_scc1 L_tg90
L_tb90:
    s_cmp_eq_u32 s38, 1
    s_cbranch_scc1 L_nb91
    s_barrier
L_nb91:
    s_waitcnt vmcnt(5)
    buffer_store_dwordx4 v[76:79], v253, s[24:27], s44 offen offset:3072 sc1
    v_permlane16_swap_b32 v112, v114
    v_permlane16_swap_b32 v113, v115
    v_permlane16_swap_b32 v100, v102
    v_permlane16_swap_b32 v101, v103
    v_permlane16_swap_b32 v96, v98
    v_permlane16_swap_b32 v97, v99
    v_permlane16_swap_b32 v108, v110
    v_permlane16_swap_b32 v109, v111
    v_mul_f32 v180, v180, v236
    v_mul_f32 v181, v181, v236
    v_mul_f32 v182, v182, v236
    v_mul_f32 v183, v183, v236
    v_mul_f32 v184, v184, v236
    v_mul_f32 v185, v185, v236
    v_mul_f32 v186, v186, v236
    v_mul_f32 v187, v187, v236
    v_cvt_pk_bf16_f32 v180, v180, v181
    v_cvt_pk_bf16_f32 v181, v182, v183
    v_cvt_pk_bf16_f32 v182, v184, v185
    v_cvt_pk_bf16_f32 v183, v186, v187
    v_mul_f32 v188, v188, v236
    s_cmp_eq_u32 s38, 2
    s_cbranch_scc1 L_c92
    s_waitcnt vmcnt(5)
    buffer_store_dwordx4 v[112:115], v253, s[24:27], s43 offen offset:128 sc1
L_c92:
    v_mul_f32 v189, v189, v236
    v_mul_f32 v190, v190, v236
    v_mul_f32 v191, v191, v236
    v_mul_f32 v192, v192, v236
    v_mul_f32 v193, v193, v236
    v_mul_f32 v194, v194, v236
    v_mul_f32 v195, v195, v236
    v_cvt_pk_bf16_f32 v184, v188, v189
    v_cvt_pk_bf16_f32 v185, v190, v191
    v_cvt_pk_bf16_f32 v186, v192, v193
    v_cvt_pk_bf16_f32 v187, v194, v195
    v_mul_f32 v196, v196, v240
    v_mul_f32 v197, v197, v240
    v_mul_f32 v198, v198, v240
    v_mul_f32 v199, v199, v240
    v_mul_f32 v200, v200, v240
    v_mul_f32 v201, v201, v240
    v_mul_f32 v202, v202, v240
    v_mul_f32 v203, v203, v240
    v_cvt_pk_bf16_f32 v188, v196, v197
    v_cvt_pk_bf16_f32 v189, v198, v199
    s_cmp_eq_u32 s38, 2
    s_cbranch_scc1 L_c93
    s_waitcnt vmcnt(5)
    buffer_store_dwordx4 v[100:103], v253, s[24:27], s43 offen offset:3200 sc1
L_c93:
    v_cvt_pk_bf16_f32 v190, v200, v201
    v_cvt_pk_bf16_f32 v191, v202, v203
    v_mul_f32 v204, v204, v240
    v_mul_f32 v205, v205, v240
    v_mul_f32 v206, v206, v240
    v_mul_f32 v207, v207, v240
    v_mul_f32 v208, v208, v240
    v_mul_f32 v209, v209, v240
    v_mul_f32 v210, v210, v240
    v_mul_f32 v211, v211, v240
    v_cvt_pk_bf16_f32 v192, v204, v205
    v_cvt_pk_bf16_f32 v193, v206, v207
    v_cvt_pk_bf16_f32 v194, v208, v209
    v_cvt_pk_bf16_f32 v195, v210, v211
    v_cndmask_b32_dpp v196, v184, v180, vcc row_ror:8 row_mask:0xf bank_mask:0xf
    v_cndmask_b32_dpp v197, v185, v181, vcc row_ror:8 row_mask:0xf bank_mask:0xf
    v_cndmask_b32_dpp v198, v186, v182, vcc row_ror:8 row_mask:0xf bank_mask:0xf
    v_cndmask_b32_dpp v199, v187, v183, vcc row_ror:8 row_mask:0xf bank_mask:0xf
    v_mov_b32_dpp v184, v180 row_ror:8 row_mask:0xf bank_mask:0x3
    v_mov_b32_dpp v185, v181 row_ror:8 row_mask:0xf bank_mask:0x3
    v_mov_b32_dpp v186, v182 row_ror:8 row_mask:0xf bank_mask:0x3
    v_mov_b32_dpp v187, v183 row_ror:8 row_mask:0xf bank_mask:0x3
    s_cmp_eq_u32 s38, 2
    s_cbranch_scc0 L_c105
    s_waitcnt vmcnt(2)
L_c105:
    s_cmp_ge_u32 s80, 3
    s_cbranch_scc1 L_tg94
L_tb94:
    s_cmp_eq_u32 s38, 1
    s_cbranch_scc1 L_nb95
    s_barrier
L_nb95:
    ds_read_b32 v254, v247
    v_cndmask_b32_dpp v180, v192, v188, vcc row_ror:8 row_mask:0xf bank_mask:0xf
    v_cndmask_b32_dpp v181, v193, v189, vcc row_ror:8 row_mask:0xf bank_mask:0xf
    v_cndmask_b32_dpp v182, v194, v190, vcc row_ror:8 row_mask:0xf bank_mask:0xf
    v_cndmask_b32_dpp v183, v195, v191, vcc row_ror:8 row_mask:0xf bank_mask:0xf
    v_mov_b32_dpp v192, v188 row_ror:8 row_mask:0xf bank_mask:0x3
    v_mov_b32_dpp v193, v189 row_ror:8 row_mask:0xf bank_mask:0x3
    v_mov_b32_dpp v194, v190 row_ror:8 row_mask:0xf bank_mask:0x3
    v_mov_b32_dpp v195, v191 row_ror:8 row_mask:0xf bank_mask:0x3
    v_permlane16_swap_b32 v196, v198
    s_cmp_eq_u32 s38, 2
    s_cbranch_scc1 L_c96
    s_waitcnt vmcnt(5)
    buffer_store_dwordx4 v[96:99], v253, s[24:27], s44 offen offset:128 sc1
L_c96:
    v_permlane16_swap_b32 v197, v199
    v_permlane16_swap_b32 v184, v186
    v_permlane16_swap_b32 v185, v187
    v_permlane16_swap_b32 v180, v182
    v_permlane16_swap_b32 v181, v183
    v_permlane16_swap_b32 v192, v194
    v_permlane16_swap_b32 v193, v195
    v_cndmask_b32_dpp v128, v136, v132, vcc row_ror:8 row_mask:0xf bank_mask:0xf
    v_cndmask_b32_dpp v129, v137, v133, vcc row_ror:8 row_mask:0xf bank_mask:0xf
    s_waitcnt lgkmcnt(0)
    v_readfirstlane_b32 s81, v254
    s_cmp_lt_i32 s81, 10
    s_cselect_b32 s80, 1, 0
    s_cmp_lt_i32 s81, 6
    s_cselect_b32 s80, 2, s80
    s_cmp_lt_i32 s81, 3
    s_cselect_b32 s80, 3, s80
    s_cmp_eq_u32 s38, 1
    s_cselect_b32 s80, 0, s80
    s_cmp_le_u32 s38, 2
    s_cselect_b32 s81, 2, 9
    s_min_u32 s80, s80, s81
    s_cmp_le_u32 s38, 2
    s_cselect_b32 s81, 1, 9
    s_min_u32 s80, s80, s81
    v_cndmask_b32_dpp v130, v138, v134, vcc row_ror:8 row_mask:0xf bank_mask:0xf
    v_cndmask_b32_dpp v131, v139, v135, vcc row_ror:8 row_mask:0xf bank_mask:0xf
    v_mov_b32_dpp v136, v132 row_ror:8 row_mask:0xf bank_mask:0x3
    v_mov_b32_dpp v137, v133 row_ror:8 row_mask:0xf bank_mask:0x3
    v_mov_b32_dpp v138, v134 row_ror:8 row_mask:0xf bank_mask:0x3
    v_mov_b32_dpp v139, v135 row_ror:8 row_mask:0xf bank_mask:0x3
    v_cndmask_b32_dpp v132, v144, v140, vcc row_ror:8 row_mask:0xf bank_mask:0xf
    v_cndmask_b32_dpp v133, v145, v141, vcc row_ror:8 row_mask:0xf bank_mask:0xf
    v_cndmask_b32_dpp v134, v146, v142, vcc row_ror:8 row_mask:0xf bank_mask:0xf
    s_cmp_eq_u32 s38, 2
    s_cbranch_scc1 L_c97
    s_waitcnt vmcnt(5)
    buffer_store_dwordx4 v[108:111], v253, s[24:27], s44 offen offset:3200 sc1
L_c97:
    v_cndmask_b32_dpp v135, v147, v143, vcc row_ror:8 row_mask:0xf bank_mask:0xf
    v_mov_b32_dpp v144, v140 row_ror:8 row_mask:0xf bank_mask:0x3
    v_mov_b32_dpp v145, v141 row_ror:8 row_mask:0xf bank_mask:0x3
    v_mov_b32_dpp v146, v142 row_ror:8 row_mask:0xf bank_mask:0x3
    v_mov_b32_dpp v147, v143 row_ror:8 row_mask:0xf bank_mask:0x3
    v_cndmask_b32_dpp v140, v152, v148, vcc row_ror:8 row_mask:0xf bank_mask:0xf
    v_cndmask_b32_dpp v141, v153, v149, vcc row_ror:8 row_mask:0xf bank_mask:0xf
    v_cndmask_b32_dpp v142, v154, v150, vcc row_ror:8 row_mask:0xf bank_mask:0xf
    v_cndmask_b32_dpp v143, v155, v151, vcc row_ror:8 row_mask:0xf bank_mask:0xf
    s_cmp_eq_u32 s38, 2
    s_cbranch_scc1 L_c98
    s_waitcnt vmcnt(5)
    buffer_store_dwordx4 v[196:199], v253, s[24:27], s43 offen offset:256 sc1
L_c98:
    v_mov_b32_dpp v152, v148 row_ror:8 row_mask:0xf bank_mask:0x3
    v_mov_b32_dpp v153, v149 row_ror:8 row_mask:0xf bank_mask:0x3
    v_mov_b32_dpp v154, v150 row_ror:8 row_mask:0xf bank_mask:0x3
    v_mov_b32_dpp v155, v151 row_ror:8 row_mask:0xf bank_mask:0x3
    v_cndmask_b32_dpp v148, v160, v156, vcc row_ror:8 row_mask:0xf bank_mask:0xf
    v_cndmask_b32_dpp v149, v161, v157, vcc row_ror:8 row_mask:0xf bank_mask:0xf
    v_cndmask_b32_dpp v150, v162, v158, vcc row_ror:8 row_mask:0xf bank_mask:0xf
    v_cndmask_b32_dpp v151, v163, v159, vcc row_ror:8 row_mask:0xf bank_mask:0xf
    v_mov_b32_dpp v160, v156 row_ror:8 row_mask:0xf bank_mask:0x3
    s_cmp_eq_u32 s38, 2
    s_cbranch_scc0 L_c99
    s_waitcnt vmcnt(5)
    buffer_store_dwordx4 v[68:71], v253, s[24:27], s43 offen offset:3072 sc1
L_c99:
    v_mov_b32_dpp v161, v157 row_ror:8 row_mask:0xf bank_mask:0x3
    v_mov_b32_dpp v162, v158 row_ror:8 row_mask:0xf bank_mask:0x3
    v_mov_b32_dpp v163, v159 row_ror:8 row_mask:0xf bank_mask:0x3
    v_cndmask_b32_dpp v156, v168, v164, vcc row_ror:8 row_mask:0xf bank_mask:0xf
    v_cndmask_b32_dpp v157, v169, v165, vcc row_ror:8 row_mask:0xf bank_mask:0xf
    v_cndmask_b32_dpp v158, v170, v166, vcc row_ror:8 row_mask:0xf bank_mask:0xf
    v_cndmask_b32_dpp v159, v171, v167, vcc row_ror:8 row_mask:0xf bank_mask:0xf
    v_mov_b32_dpp v168, v164 row_ror:8 row_mask:0xf bank_mask:0x3
    v_mov_b32_dpp v169, v165 row_ror:8 row_mask:0xf bank_mask:0x3
    s_cmp_eq_u32 s38, 2
    s_cbranch_scc0 L_c100
    s_waitcnt vmcnt(5)
    buffer_store_dwordx4 v[64:67], v253, s[24:27], s44 offen sc1
L_c100:
    v_mov_b32_dpp v170, v166 row_ror:8 row_mask:0xf bank_mask:0x3
    v_mov_b32_dpp v171, v167 row_ror:8 row_mask:0xf bank_mask:0x3
    v_cndmask_b32_dpp v164, v176, v172, vcc row_ror:8 row_mask:0xf bank_mask:0xf
    v_cndmask_b32_dpp v165, v177, v173, vcc row_ror:8 row_mask:0xf bank_mask:0xf
    v_cndmask_b32_dpp v166, v178, v174, vcc row_ror:8 row_mask:0xf bank_mask:0xf
    v_cndmask_b32_dpp v167, v179, v175, vcc row_ror:8 row_mask:0xf bank_mask:0xf
    v_add_u32 v249, s37, v247
    v_xor_b32 v251, 64, v249
    s_nop 0
    ds_read_b128 v[212:215], v249 offset:0
    ds_read_b128 v[216:219], v249 offset:6144
    ds_read_b128 v[220:223], v249 offset:12288
    ds_read_b128 v[224:227], v249 offset:18432
    ds_read_b128 v[228:231], v251 offset:0
    s_add_u32 s37, s37, 24576
    s_cmp_eq_u32 s37, 147584
    s_cselect_b32 s37, 128, s37
    s_cselect_b32 s28, s29, 24576
    v_mov_b32_dpp v176, v172 row_ror:8 row_mask:0xf bank_mask:0x3
    v_mov_b32_dpp v177, v173 row_ror:8 row_mask:0xf bank_mask:0x3
    v_mov_b32_dpp v178, v174 row_ror:8 row_mask:0xf bank_mask:0x3
    v_mov_b32_dpp v179, v175 row_ror:8 row_mask:0xf bank_mask:0x3
    s_cmp_ge_u32 s80, 1
    s_cbranch_scc1 L_tg101
L_tb101:
    s_cmp_eq_u32 s38, 1
    s_cbranch_scc1 L_nb102
    s_barrier
L_nb102:
    s_mov_b32 s34, s35
    s_add_u32 s35, s35, 25165824
    s_add_u32 s42, s35, 6144
    s_sub_u32 s38, s38, 1
    s_cmp_lg_u32 s38, 0
    s_cbranch_scc1 L_headB
    buffer_store_dwordx4 v[184:187], v253, s[24:27], s43 offen offset:3328 sc1
    buffer_store_dwordx4 v[180:183], v253, s[24:27], s44 offen offset:256 sc1
    buffer_store_dwordx4 v[192:195], v253, s[24:27], s44 offen offset:3328 sc1
L_fin:
L_end:
    s_endpgm
L_tg4:
    s_waitcnt vmcnt(2)
    s_branch L_tb4
L_tg5:
    s_waitcnt vmcnt(2)
    s_branch L_tb5
L_tg6:
    s_waitcnt vmcnt(2)
    s_branch L_tb6
L_tg7:
    s_waitcnt vmcnt(2)
    s_branch L_tb7
L_tg8:
    s_waitcnt vmcnt(2)
    s_branch L_tb8
L_tg15:
    s_waitcnt vmcnt(2)
    s_branch L_tb15
L_tg21:
    s_waitcnt vmcnt(2)
    s_branch L_tb21
L_tg26:
    s_waitcnt vmcnt(2)
    s_branch L_tb26
L_tg30:
    s_waitcnt vmcnt(2)
    s_branch L_tb30
L_tg33:
    s_waitcnt vmcnt(2)
    s_branch L_tb33
L_tg36:
    s_waitcnt vmcnt(2)
    s_branch L_tb36
L_tg38:
    s_waitcnt vmcnt(2)
    s_branch L_tb38
L_tg40:
    s_waitcnt vmcnt(2)
    s_branch L_tb40
L_tg42:
    s_waitcnt vmcnt(2)
    s_branch L_tb42
L_tg44:
    s_waitcnt vmcnt(2)
    s_branch L_tb44
L_tg46:
    s_waitcnt vmcnt(2)
    s_branch L_tb46
L_tg52:
    s_waitcnt vmcnt(2)
    s_branch L_tb52
L_tg54:
    s_waitcnt vmcnt(2)
    s_branch L_tb54
L_tg56:
    s_waitcnt vmcnt(2)
    s_branch L_tb56
L_tg57:
    s_waitcnt vmcnt(2)
    s_branch L_tb57
L_tg58:
    s_waitcnt vmcnt(2)
    s_branch L_tb58
L_tg63:
    s_waitcnt vmcnt(2)
    s_branch L_tb63
L_tg69:
    s_waitcnt vmcnt(2)
    s_branch L_tb69
L_tg74:
    s_waitcnt vmcnt(2)
    s_branch L_tb74
L_tg78:
    s_waitcnt vmcnt(2)
    s_branch L_tb78
L_tg80:
    s_waitcnt vmcnt(2)
    s_branch L_tb80
L_tg82:
    s_waitcnt vmcnt(2)
    s_branch L_tb82
L_tg84:
    s_waitcnt vmcnt(2)
    s_branch L_tb84
L_tg86:
    s_waitcnt vmcnt(2)
    s_branch L_tb86
L_tg90:
    s_waitcnt vmcnt(2)
    s_branch L_tb90
L_tg94:
    s_waitcnt vmcnt(2)
    s_branch L_tb94
L_tg101:
    s_waitcnt vmcnt(2)
    s_branch L_tb101
    s_endpgm
.section .rodata,"a"
.p2align 6
.amdhsa_kernel standalone__mha_softmax__near_ridge_kernel
  .amdhsa_next_free_vgpr 256
  .amdhsa_next_free_sgpr 88
  .amdhsa_accum_offset 256
  .amdhsa_group_segment_fixed_size 0
  .amdhsa_kernarg_size 48
  .amdhsa_user_sgpr_count 2
  .amdhsa_user_sgpr_kernarg_segment_ptr 1
  .amdhsa_system_sgpr_workgroup_id_x 1
.end_amdhsa_kernel
```
